```python
import torch

def _softmax(x, axis=-1):
    return torch.softmax(x, dim=axis)
def _gelu(x):
    return torch.nn.functional.gelu(x, approximate="tanh")
def _silu(x):
    return torch.nn.functional.silu(x)
def _sigmoid(x):
    return torch.sigmoid(x)
def _layernorm(x, axis=-1, eps=1e-5):
    m = x.mean(dim=axis, keepdim=True)
    v = x.var(dim=axis, keepdim=True, unbiased=False)
    return (x - m) / torch.sqrt(v + eps)
def _scatter_add(tgt, idx, src, axis=0):
    return tgt.clone().index_add_(axis, idx, src)
def _segment_sum(src, seg, n):
    out = torch.zeros((n,) + src.shape[1:], dtype=src.dtype)
    return out.index_add_(0, seg, src)
def _pad(x, pw):
    flat = tuple(v for pair in reversed(pw) for v in pair)
    return torch.nn.functional.pad(x, flat)

kernel_name = 'gated_mix__ssm_conv_s4d__softmax_full_mha__prompt'

def setup_inputs():

    _w = (lambda a: (lambda t: t.to(torch.bfloat16) if t.is_floating_point() else t)(torch.as_tensor(a)))
    def _A_setup():
        Bsz, L, D, N = 1, 2048, 448, 256
        return {
            "u": _w((lambda *s: torch.randn(*s, dtype=torch.bfloat16) * 0.05)(Bsz, L, D)),
            "log_A_real": _w((lambda *s: torch.randn(*s, dtype=torch.bfloat16) * 3.2)(D, N) * 0.5),
            "A_imag": _w((lambda *s: torch.randn(*s, dtype=torch.bfloat16) * 0.05)(D, N) * 3.14),
            "C_real": _w((lambda *s: torch.randn(*s, dtype=torch.bfloat16) * 0.8)(D, N) / N ** 0.5),
            "C_imag": _w((lambda *s: torch.randn(*s, dtype=torch.bfloat16) * 0.8)(D, N) / N ** 0.5),
            "log_dt": _w((lambda *s: torch.randn(*s, dtype=torch.bfloat16) * 0.05)(D) * 0.5 - 4.0),
            "D_skip": _w((lambda *s: torch.randn(*s, dtype=torch.bfloat16) * 0.1)(D)),
        }
    _A_in = _A_setup()

    def _B_setup():
        B, S, D = 1, 2048, 448
        return {
            "x": _w((lambda *s: torch.randn(*s, dtype=torch.bfloat16) * 0.05)(B, S, D)),
            "wqkv": _w((lambda *s: torch.randn(*s, dtype=torch.bfloat16) * 0.8)(D, 3 * D)),
            "wo": _w((lambda *s: torch.randn(*s, dtype=torch.bfloat16) * 0.05)(D, D)),
        }
    _B_in = _B_setup()

    return {
        "A_u": _A_in["u"],
        "A_log_A_real": _A_in["log_A_real"],
        "A_A_imag": _A_in["A_imag"],
        "A_C_real": _A_in["C_real"],
        "A_C_imag": _A_in["C_imag"],
        "A_log_dt": _A_in["log_dt"],
        "A_D_skip": _A_in["D_skip"],
        "B_x": _B_in["x"],
        "B_wqkv": _B_in["wqkv"],
        "B_wo": _B_in["wo"],
        "gate_w": _w((lambda *s: torch.randn(*s, dtype=torch.bfloat16) * 0.05)(448) * 16.0),
    }

def reference(A_u, A_log_A_real, A_A_imag, A_C_real, A_C_imag, A_log_dt, A_D_skip, B_x, B_wqkv, B_wo, gate_w):
    def _A_ref(u, log_A_real, A_imag, C_real, C_imag, log_dt, D_skip):
        L = u.shape[1]
        dt = torch.exp(log_dt)
        A = -torch.exp(log_A_real) + 1j * A_imag
        C = (C_real + 1j * C_imag) * dt[:, None]
        pos = (lambda x, dt: x.to(dt))(torch.arange(L), log_dt.dtype)
        P = torch.exp((A * dt[:, None])[:, :, None] * pos[None, None, :])
        K = 2.0 * torch.einsum("dn,dnl->dl", C, P).real
        L2 = 2 * L
        u_t = (lambda x, *d: x.permute(*d))(u, 0, 2, 1)
        Kf = (lambda x, *a, **k: torch.fft.rfft(x.float(), *a, **k))(K, L2)
        Uf = (lambda x, *a, **k: torch.fft.rfft(x.float(), *a, **k))(u_t, L2)
        y = (lambda x, *a, **k: torch.fft.irfft(x, *a, **k).to(torch.bfloat16))(Uf * Kf[None, :, :], L2)[:, :, :L]
        y = (lambda x, *d: x.permute(*d))(y, 0, 2, 1)
        return y + u * D_skip[None, None, :]

    def _B_ref(x, wqkv, wo):
        B, S, D = x.shape
        H = 16; Dh = D // H
        qkv = (lambda x, *d: x.permute(*d))((x @ wqkv).reshape(B, S, 3, H, Dh), 2, 0, 3, 1, 4)
        q, k, v = qkv[0], qkv[1], qkv[2]
        scale = Dh ** -0.5
        scores = torch.einsum("bhqd,bhkd->bhqk", q, k) * scale
        p = _softmax(scores, axis=-1)
        o = torch.einsum("bhqk,bhkd->bhqd", p, v)
        return (lambda x, *d: x.permute(*d))(o, 0, 2, 1, 3).reshape(B, S, D) @ wo

    x = A_u
    g = _sigmoid((x * gate_w).sum(-1, keepdims=True))
    a = _A_ref(x, A_log_A_real, A_A_imag, A_C_real, A_C_imag, A_log_dt, A_D_skip)
    b = _B_ref(x, B_wqkv, B_wo)
    return g * a + (1 - g) * b
```

```asm
; @launch grid=(256,1,1) block=(512,1,1) lds=163840
.amdgcn_target "amdgcn-amd-amdhsa--gfx950"
.text
.globl gated_mix__ssm_conv_s4d__softmax_full_mha__prompt_kernel
.p2align 8
.type gated_mix__ssm_conv_s4d__softmax_full_mha__prompt_kernel,@function
gated_mix__ssm_conv_s4d__softmax_full_mha__prompt_kernel:
s_cmp_ge_u32 s2, 256
s_cbranch_scc1 KEND
s_load_dwordx16 s[4:19], s[0:1], 0
s_load_dwordx8 s[20:27], s[0:1], 64
s_load_dwordx4 s[28:31], s[0:1], 96
v_lshrrev_b32 v6, 6, v0
s_nop 0
v_readfirstlane_b32 s3, v6
v_and_b32 v0, 63, v0
v_and_b32 v1, 31, v0
v_lshrrev_b32 v2, 5, v0
v_mov_b32 v4, 155648
v_mov_b32 v5, 1
s_and_b32 s34, s2, 7
s_lshr_b32 s35, s2, 3
s_mov_b32 s36, 0x20000
v_lshlrev_b32 v6, 2, v0
v_add_u32 v6, 155648, v6
v_mov_b32 v7, 0
v_cmp_gt_u32 vcc, 32, v0
s_and_saveexec_b64 s[50:51], vcc
ds_write_b32 v6, v7
s_mov_b64 exec, -1
v_mov_b32 v6, 0
s_waitcnt lgkmcnt(0)
global_load_dword v3, v6, s[30:31] sc1
s_cmp_ge_u32 s3, 4
s_cbranch_scc1 SPATH
s_setprio 3
s_lshr_b32 s52, s34, 1
s_lshl_b32 s52, s52, 2
s_lshr_b32 s40, s35, 3
s_add_u32 s52, s52, s40
s_and_b32 s40, s34, 1
s_lshl_b32 s40, s40, 3
s_and_b32 s53, s35, 7
s_add_u32 s53, s53, s40
s_mov_b32 s32, s53
s_mov_b32 s44, s20
s_mov_b32 s45, s21
s_mov_b32 s46, 1204224
s_mov_b32 s47, 0x20000
s_lshl_b32 s40, s32, 7
s_lshl_b32 s41, s3, 5
s_add_u32 s40, s40, s41
s_mul_i32 s40, s40, 896
v_lshrrev_b32 v6, 3, v0
v_mul_u32_u24 v6, 896, v6
v_and_b32 v7, 7, v0
v_lshlrev_b32 v7, 4, v7
v_add3_u32 v104, v6, v7, s40
v_add_u32 v105, 7168, v104
v_add_u32 v106, 14336, v104
v_add_u32 v107, 21504, v104
s_lshl_b32 s41, s3, 4
s_mul_i32 s41, s41, 2688
s_mul_i32 s43, s52, 56
s_and_b32 s43, s43, -16
s_add_u32 s41, s41, s43
v_add_u32 v6, 0, v0
v_mul_u32_u24 v7, 0x5556, v6
v_lshrrev_b32 v7, 18, v7
v_mul_u32_u24 v8, 12, v7
v_sub_u32 v6, v6, v8
v_lshrrev_b32 v8, 2, v6
v_mul_u32_u24 v8, 896, v8
v_and_b32 v6, 3, v6
v_lshl_add_u32 v6, v6, 4, v8
v_mul_u32_u24 v7, 2688, v7
v_add3_u32 v108, v6, v7, s41
v_add_u32 v6, 64, v0
v_mul_u32_u24 v7, 0x5556, v6
v_lshrrev_b32 v7, 18, v7
v_mul_u32_u24 v8, 12, v7
v_sub_u32 v6, v6, v8
v_lshrrev_b32 v8, 2, v6
v_mul_u32_u24 v8, 896, v8
v_and_b32 v6, 3, v6
v_lshl_add_u32 v6, v6, 4, v8
v_mul_u32_u24 v7, 2688, v7
v_add3_u32 v109, v6, v7, s41
v_add_u32 v6, 128, v0
v_mul_u32_u24 v7, 0x5556, v6
v_lshrrev_b32 v7, 18, v7
v_mul_u32_u24 v8, 12, v7
v_sub_u32 v6, v6, v8
v_lshrrev_b32 v8, 2, v6
v_mul_u32_u24 v8, 896, v8
v_and_b32 v6, 3, v6
v_lshl_add_u32 v6, v6, 4, v8
v_mul_u32_u24 v7, 2688, v7
v_add3_u32 v110, v6, v7, s41
v_lshrrev_b32 v6, 4, v0
v_and_b32 v7, 15, v0
s_lshl_b32 s41, s3, 4
v_add_u32 v7, s41, v7
v_lshl_add_u32 v8, v6, 6, v7
v_lshlrev_b32 v8, 1, v8
v_min_u32 v9, 2, v6
v_lshl_add_u32 v9, v9, 6, v7
v_lshlrev_b32 v9, 1, v9
v_add_u32 v9, 512, v9
v_mul_u32_u24 v7, 192, v7
v_mul_u32_u24 v6, 12288, v6
s_and_b32 s41, s52, 1
s_lshl_b32 s41, s41, 3
s_add_u32 s41, s41, 56
v_add3_u32 v114, v6, v7, s41
s_mul_i32 s42, s3, 3072
s_barrier
global_load_ushort v112, v8, s[24:25]
global_load_ushort v113, v9, s[24:25]
global_load_dwordx4 v[128:131], v104, s[4:5] offset:0
global_load_dwordx4 v[132:135], v105, s[4:5] offset:0
global_load_dwordx4 v[136:139], v106, s[4:5] offset:0
global_load_dwordx4 v[140:143], v107, s[4:5] offset:0
s_add_u32 m0, s42, 0
s_mov_b32 s43, 0
buffer_load_dwordx4 v108, s[44:47], s43 offen lds
s_add_u32 m0, s42, 1024
s_mov_b32 s43, 0
buffer_load_dwordx4 v109, s[44:47], s43 offen lds
s_add_u32 m0, s42, 2048
s_mov_b32 s43, 0
buffer_load_dwordx4 v110, s[44:47], s43 offen lds
global_load_dwordx4 v[144:147], v104, s[4:5] offset:128
global_load_dwordx4 v[148:151], v105, s[4:5] offset:128
global_load_dwordx4 v[152:155], v106, s[4:5] offset:128
global_load_dwordx4 v[156:159], v107, s[4:5] offset:128
s_add_u32 m0, s42, 12288
s_mov_b32 s43, 172032
buffer_load_dwordx4 v108, s[44:47], s43 offen lds
s_add_u32 m0, s42, 13312
s_mov_b32 s43, 172032
buffer_load_dwordx4 v109, s[44:47], s43 offen lds
s_add_u32 m0, s42, 14336
s_mov_b32 s43, 172032
buffer_load_dwordx4 v110, s[44:47], s43 offen lds
global_load_dwordx4 v[160:163], v104, s[4:5] offset:256
global_load_dwordx4 v[164:167], v105, s[4:5] offset:256
global_load_dwordx4 v[168:171], v106, s[4:5] offset:256
global_load_dwordx4 v[172:175], v107, s[4:5] offset:256
s_add_u32 m0, s42, 24576
s_mov_b32 s43, 344064
buffer_load_dwordx4 v108, s[44:47], s43 offen lds
s_add_u32 m0, s42, 25600
s_mov_b32 s43, 344064
buffer_load_dwordx4 v109, s[44:47], s43 offen lds
s_add_u32 m0, s42, 26624
s_mov_b32 s43, 344064
buffer_load_dwordx4 v110, s[44:47], s43 offen lds
global_load_dwordx4 v[176:179], v104, s[4:5] offset:384
global_load_dwordx4 v[180:183], v105, s[4:5] offset:384
global_load_dwordx4 v[184:187], v106, s[4:5] offset:384
global_load_dwordx4 v[188:191], v107, s[4:5] offset:384
s_add_u32 m0, s42, 36864
s_mov_b32 s43, 516096
buffer_load_dwordx4 v108, s[44:47], s43 offen lds
s_add_u32 m0, s42, 37888
s_mov_b32 s43, 516096
buffer_load_dwordx4 v109, s[44:47], s43 offen lds
s_add_u32 m0, s42, 38912
s_mov_b32 s43, 516096
buffer_load_dwordx4 v110, s[44:47], s43 offen lds
global_load_dwordx4 v[192:195], v104, s[4:5] offset:512
global_load_dwordx4 v[196:199], v105, s[4:5] offset:512
global_load_dwordx4 v[200:203], v106, s[4:5] offset:512
global_load_dwordx4 v[204:207], v107, s[4:5] offset:512
s_add_u32 m0, s42, 49152
s_mov_b32 s43, 688128
buffer_load_dwordx4 v108, s[44:47], s43 offen lds
s_add_u32 m0, s42, 50176
s_mov_b32 s43, 688128
buffer_load_dwordx4 v109, s[44:47], s43 offen lds
s_add_u32 m0, s42, 51200
s_mov_b32 s43, 688128
buffer_load_dwordx4 v110, s[44:47], s43 offen lds
global_load_dwordx4 v[208:211], v104, s[4:5] offset:640
global_load_dwordx4 v[212:215], v105, s[4:5] offset:640
global_load_dwordx4 v[216:219], v106, s[4:5] offset:640
global_load_dwordx4 v[220:223], v107, s[4:5] offset:640
s_add_u32 m0, s42, 61440
s_mov_b32 s43, 860160
buffer_load_dwordx4 v108, s[44:47], s43 offen lds
s_add_u32 m0, s42, 62464
s_mov_b32 s43, 860160
buffer_load_dwordx4 v109, s[44:47], s43 offen lds
s_add_u32 m0, s42, 63488
s_mov_b32 s43, 860160
buffer_load_dwordx4 v110, s[44:47], s43 offen lds
global_load_dwordx4 v[224:227], v104, s[4:5] offset:768
global_load_dwordx4 v[228:231], v105, s[4:5] offset:768
global_load_dwordx4 v[232:235], v106, s[4:5] offset:768
global_load_dwordx4 v[236:239], v107, s[4:5] offset:768
s_add_u32 m0, s42, 73728
s_mov_b32 s43, 1032192
buffer_load_dwordx4 v108, s[44:47], s43 offen lds
s_add_u32 m0, s42, 74752
s_mov_b32 s43, 1032192
buffer_load_dwordx4 v109, s[44:47], s43 offen lds
s_add_u32 m0, s42, 75776
s_mov_b32 s43, 1032192
buffer_load_dwordx4 v110, s[44:47], s43 offen lds
s_lshl_b32 s40, s3, 12
s_add_u32 s40, s40, 86016
v_lshrrev_b32 v6, 3, v0
v_lshlrev_b32 v6, 7, v6
v_add_u32 v6, s40, v6
v_lshrrev_b32 v7, 4, v0
v_and_b32 v8, 7, v0
v_xor_b32 v9, v8, v7
v_lshlrev_b32 v8, 4, v9
v_add_u32 v8, v6, v8
v_xor_b32 v9, 4, v9
v_lshlrev_b32 v9, 4, v9
v_add_u32 v9, v6, v9
v_lshrrev_b32 v6, 3, v1
v_lshlrev_b32 v6, 10, v6
v_and_b32 v7, 7, v1
v_lshlrev_b32 v7, 7, v7
v_add3_u32 v6, v6, v7, s40
v_lshrrev_b32 v7, 1, v1
v_and_b32 v7, 7, v7
v_xor_b32 v7, v7, v2
v_xor_b32 v10, 0, v7
v_lshlrev_b32 v10, 4, v10
v_add_u32 v10, v6, v10
v_xor_b32 v11, 2, v7
v_lshlrev_b32 v11, 4, v11
v_add_u32 v11, v6, v11
v_xor_b32 v12, 4, v7
v_lshlrev_b32 v12, 4, v12
v_add_u32 v12, v6, v12
v_xor_b32 v13, 6, v7
v_lshlrev_b32 v13, 4, v13
v_add_u32 v13, v6, v13
v_lshrrev_b32 v6, 2, v0
v_and_b32 v6, 3, v6
v_lshlrev_b32 v7, 3, v2
v_add_u32 v6, v6, v7
v_mul_u32_u24 v6, 192, v6
v_lshrrev_b32 v7, 4, v0
v_and_b32 v7, 1, v7
v_lshlrev_b32 v7, 5, v7
v_and_b32 v14, 3, v0
v_lshlrev_b32 v14, 3, v14
v_add3_u32 v14, v14, v6, v7
s_and_b32 s41, s52, 1
s_lshl_b32 s41, s41, 3
v_add_u32 v14, s41, v14
v_add_u32 v15, 49152, v14
v_cmp_eq_u32 s[54:55], 1, v2
v_cmp_le_u32 s[56:57], 28, v1
s_waitcnt vmcnt(35)
s_mov_b32 exec_hi, 0
ds_write_b16 v114, v112
s_mov_b32 exec_hi, -1
s_mov_b64 exec, 1
ds_add_u32 v4, v5 offset:0
s_mov_b64 exec, -1
ds_write_b128 v8, v[128:131] offset:0
ds_write_b128 v9, v[132:135] offset:1024
ds_write_b128 v8, v[136:139] offset:2048
ds_write_b128 v9, v[140:143] offset:3072
ds_read_b128 v[64:67], v10
ds_read_b128 v[68:71], v11
ds_read_b128 v[72:75], v12
ds_read_b128 v[76:79], v13
W_1:
ds_read_b32 v6, v4 offset:0
s_waitcnt lgkmcnt(0)
v_readfirstlane_b32 s39, v6
s_cmp_ge_u32 s39, 4
s_cbranch_scc1 D_2
s_sub_u32 s36, s36, 1
s_cbranch_scc0 W_1
s_mov_b32 s36, 0
D_2:
ds_read_b64_tr_b16 v[80:81], v14 offset:0
ds_read_b64_tr_b16 v[82:83], v14 offset:768
ds_read_b64_tr_b16 v[84:85], v14 offset:64
ds_read_b64_tr_b16 v[86:87], v14 offset:832
ds_read_b64_tr_b16 v[88:89], v14 offset:128
ds_read_b64_tr_b16 v[90:91], v14 offset:896
ds_read_b64_tr_b16 v[92:93], v14 offset:3072
ds_read_b64_tr_b16 v[94:95], v14 offset:3840
ds_read_b64_tr_b16 v[96:97], v14 offset:3136
ds_read_b64_tr_b16 v[98:99], v14 offset:3904
ds_read_b64_tr_b16 v[100:101], v14 offset:3200
ds_read_b64_tr_b16 v[102:103], v14 offset:3968
s_waitcnt lgkmcnt(6)
v_mfma_f32_32x32x16_bf16 v[16:31], v[80:83], v[64:67], 0
v_mfma_f32_32x32x16_bf16 v[32:47], v[84:87], v[64:67], 0
v_mfma_f32_32x32x16_bf16 v[48:63], v[64:67], v[88:91], 0
ds_read_b64_tr_b16 v[80:81], v14 offset:6144
ds_read_b64_tr_b16 v[82:83], v14 offset:6912
ds_read_b64_tr_b16 v[84:85], v14 offset:6208
ds_read_b64_tr_b16 v[86:87], v14 offset:6976
ds_read_b64_tr_b16 v[88:89], v14 offset:6272
ds_read_b64_tr_b16 v[90:91], v14 offset:7040
s_waitcnt lgkmcnt(6)
v_mfma_f32_32x32x16_bf16 v[16:31], v[92:95], v[68:71], v[16:31]
v_mfma_f32_32x32x16_bf16 v[32:47], v[96:99], v[68:71], v[32:47]
v_mfma_f32_32x32x16_bf16 v[48:63], v[68:71], v[100:103], v[48:63]
ds_read_b64_tr_b16 v[92:93], v14 offset:9216
ds_read_b64_tr_b16 v[94:95], v14 offset:9984
ds_read_b64_tr_b16 v[96:97], v14 offset:9280
ds_read_b64_tr_b16 v[98:99], v14 offset:10048
ds_read_b64_tr_b16 v[100:101], v14 offset:9344
ds_read_b64_tr_b16 v[102:103], v14 offset:10112
s_waitcnt lgkmcnt(6)
v_mfma_f32_32x32x16_bf16 v[16:31], v[80:83], v[72:75], v[16:31]
v_mfma_f32_32x32x16_bf16 v[32:47], v[84:87], v[72:75], v[32:47]
v_mfma_f32_32x32x16_bf16 v[48:63], v[72:75], v[88:91], v[48:63]
s_waitcnt lgkmcnt(0)
v_mfma_f32_32x32x16_bf16 v[16:31], v[92:95], v[76:79], v[16:31]
v_mfma_f32_32x32x16_bf16 v[32:47], v[96:99], v[76:79], v[32:47]
v_mfma_f32_32x32x16_bf16 v[48:63], v[76:79], v[100:103], v[48:63]
ds_write_b128 v8, v[144:147] offset:0
ds_write_b128 v9, v[148:151] offset:1024
ds_write_b128 v8, v[152:155] offset:2048
ds_write_b128 v9, v[156:159] offset:3072
ds_read_b128 v[64:67], v10
ds_read_b128 v[68:71], v11
ds_read_b128 v[72:75], v12
ds_read_b128 v[76:79], v13
ds_read_b64_tr_b16 v[80:81], v14 offset:12288
ds_read_b64_tr_b16 v[82:83], v14 offset:13056
ds_read_b64_tr_b16 v[84:85], v14 offset:12352
ds_read_b64_tr_b16 v[86:87], v14 offset:13120
ds_read_b64_tr_b16 v[88:89], v14 offset:12416
ds_read_b64_tr_b16 v[90:91], v14 offset:13184
ds_read_b64_tr_b16 v[92:93], v14 offset:15360
ds_read_b64_tr_b16 v[94:95], v14 offset:16128
ds_read_b64_tr_b16 v[96:97], v14 offset:15424
ds_read_b64_tr_b16 v[98:99], v14 offset:16192
ds_read_b64_tr_b16 v[100:101], v14 offset:15488
ds_read_b64_tr_b16 v[102:103], v14 offset:16256
s_waitcnt lgkmcnt(6)
v_mfma_f32_32x32x16_bf16 v[16:31], v[80:83], v[64:67], v[16:31]
v_mfma_f32_32x32x16_bf16 v[32:47], v[84:87], v[64:67], v[32:47]
v_mfma_f32_32x32x16_bf16 v[48:63], v[64:67], v[88:91], v[48:63]
ds_read_b64_tr_b16 v[80:81], v14 offset:18432
ds_read_b64_tr_b16 v[82:83], v14 offset:19200
ds_read_b64_tr_b16 v[84:85], v14 offset:18496
ds_read_b64_tr_b16 v[86:87], v14 offset:19264
ds_read_b64_tr_b16 v[88:89], v14 offset:18560
ds_read_b64_tr_b16 v[90:91], v14 offset:19328
s_waitcnt lgkmcnt(6)
v_mfma_f32_32x32x16_bf16 v[16:31], v[92:95], v[68:71], v[16:31]
v_mfma_f32_32x32x16_bf16 v[32:47], v[96:99], v[68:71], v[32:47]
v_mfma_f32_32x32x16_bf16 v[48:63], v[68:71], v[100:103], v[48:63]
ds_read_b64_tr_b16 v[92:93], v14 offset:21504
ds_read_b64_tr_b16 v[94:95], v14 offset:22272
ds_read_b64_tr_b16 v[96:97], v14 offset:21568
ds_read_b64_tr_b16 v[98:99], v14 offset:22336
ds_read_b64_tr_b16 v[100:101], v14 offset:21632
ds_read_b64_tr_b16 v[102:103], v14 offset:22400
s_waitcnt lgkmcnt(6)
v_mfma_f32_32x32x16_bf16 v[16:31], v[80:83], v[72:75], v[16:31]
v_mfma_f32_32x32x16_bf16 v[32:47], v[84:87], v[72:75], v[32:47]
v_mfma_f32_32x32x16_bf16 v[48:63], v[72:75], v[88:91], v[48:63]
s_waitcnt lgkmcnt(0)
v_mfma_f32_32x32x16_bf16 v[16:31], v[92:95], v[76:79], v[16:31]
v_mfma_f32_32x32x16_bf16 v[32:47], v[96:99], v[76:79], v[32:47]
v_mfma_f32_32x32x16_bf16 v[48:63], v[76:79], v[100:103], v[48:63]
s_waitcnt vmcnt(14)
s_mov_b32 exec_lo, 0
ds_write_b16 v114, v112
s_mov_b64 exec, 0xffff
ds_write_b16 v114, v113 offset:49152
s_mov_b64 exec, -1
s_mov_b64 exec, 1
ds_add_u32 v4, v5 offset:4
s_mov_b64 exec, -1
ds_write_b128 v8, v[160:163] offset:0
ds_write_b128 v9, v[164:167] offset:1024
ds_write_b128 v8, v[168:171] offset:2048
ds_write_b128 v9, v[172:175] offset:3072
ds_read_b128 v[64:67], v10
ds_read_b128 v[68:71], v11
ds_read_b128 v[72:75], v12
ds_read_b128 v[76:79], v13
W_3:
ds_read_b32 v6, v4 offset:4
s_waitcnt lgkmcnt(0)
v_readfirstlane_b32 s39, v6
s_cmp_ge_u32 s39, 4
s_cbranch_scc1 D_4
s_sub_u32 s36, s36, 1
s_cbranch_scc0 W_3
s_mov_b32 s36, 0
D_4:
ds_read_b64_tr_b16 v[80:81], v14 offset:24576
ds_read_b64_tr_b16 v[82:83], v14 offset:25344
ds_read_b64_tr_b16 v[84:85], v14 offset:24640
ds_read_b64_tr_b16 v[86:87], v14 offset:25408
ds_read_b64_tr_b16 v[88:89], v14 offset:24704
ds_read_b64_tr_b16 v[90:91], v14 offset:25472
ds_read_b64_tr_b16 v[92:93], v14 offset:27648
ds_read_b64_tr_b16 v[94:95], v14 offset:28416
ds_read_b64_tr_b16 v[96:97], v14 offset:27712
ds_read_b64_tr_b16 v[98:99], v14 offset:28480
ds_read_b64_tr_b16 v[100:101], v14 offset:27776
ds_read_b64_tr_b16 v[102:103], v14 offset:28544
s_waitcnt lgkmcnt(6)
v_mfma_f32_32x32x16_bf16 v[16:31], v[80:83], v[64:67], v[16:31]
v_mfma_f32_32x32x16_bf16 v[32:47], v[84:87], v[64:67], v[32:47]
v_mfma_f32_32x32x16_bf16 v[48:63], v[64:67], v[88:91], v[48:63]
ds_read_b64_tr_b16 v[80:81], v14 offset:30720
ds_read_b64_tr_b16 v[82:83], v14 offset:31488
ds_read_b64_tr_b16 v[84:85], v14 offset:30784
ds_read_b64_tr_b16 v[86:87], v14 offset:31552
ds_read_b64_tr_b16 v[88:89], v14 offset:30848
ds_read_b64_tr_b16 v[90:91], v14 offset:31616
s_waitcnt lgkmcnt(6)
v_mfma_f32_32x32x16_bf16 v[16:31], v[92:95], v[68:71], v[16:31]
v_mfma_f32_32x32x16_bf16 v[32:47], v[96:99], v[68:71], v[32:47]
v_mfma_f32_32x32x16_bf16 v[48:63], v[68:71], v[100:103], v[48:63]
ds_read_b64_tr_b16 v[92:93], v14 offset:33792
ds_read_b64_tr_b16 v[94:95], v14 offset:34560
ds_read_b64_tr_b16 v[96:97], v14 offset:33856
ds_read_b64_tr_b16 v[98:99], v14 offset:34624
ds_read_b64_tr_b16 v[100:101], v14 offset:33920
ds_read_b64_tr_b16 v[102:103], v14 offset:34688
s_waitcnt lgkmcnt(6)
v_mfma_f32_32x32x16_bf16 v[16:31], v[80:83], v[72:75], v[16:31]
v_mfma_f32_32x32x16_bf16 v[32:47], v[84:87], v[72:75], v[32:47]
v_mfma_f32_32x32x16_bf16 v[48:63], v[72:75], v[88:91], v[48:63]
s_waitcnt lgkmcnt(0)
v_mfma_f32_32x32x16_bf16 v[16:31], v[92:95], v[76:79], v[16:31]
v_mfma_f32_32x32x16_bf16 v[32:47], v[96:99], v[76:79], v[32:47]
v_mfma_f32_32x32x16_bf16 v[48:63], v[76:79], v[100:103], v[48:63]
s_mov_b64 exec, 1
ds_add_u32 v4, v5 offset:76
s_mov_b64 exec, -1
ds_write_b128 v8, v[176:179] offset:0
ds_write_b128 v9, v[180:183] offset:1024
ds_write_b128 v8, v[184:187] offset:2048
ds_write_b128 v9, v[188:191] offset:3072
ds_read_b128 v[64:67], v10
ds_read_b128 v[68:71], v11
ds_read_b128 v[72:75], v12
ds_read_b128 v[76:79], v13
ds_read_b64_tr_b16 v[80:81], v14 offset:36864
ds_read_b64_tr_b16 v[82:83], v14 offset:37632
ds_read_b64_tr_b16 v[84:85], v14 offset:36928
ds_read_b64_tr_b16 v[86:87], v14 offset:37696
ds_read_b64_tr_b16 v[88:89], v14 offset:36992
ds_read_b64_tr_b16 v[90:91], v14 offset:37760
ds_read_b64_tr_b16 v[92:93], v14 offset:39936
ds_read_b64_tr_b16 v[94:95], v14 offset:40704
ds_read_b64_tr_b16 v[96:97], v14 offset:40000
ds_read_b64_tr_b16 v[98:99], v14 offset:40768
ds_read_b64_tr_b16 v[100:101], v14 offset:40064
ds_read_b64_tr_b16 v[102:103], v14 offset:40832
s_waitcnt lgkmcnt(6)
v_mfma_f32_32x32x16_bf16 v[16:31], v[80:83], v[64:67], v[16:31]
v_mfma_f32_32x32x16_bf16 v[32:47], v[84:87], v[64:67], v[32:47]
v_mfma_f32_32x32x16_bf16 v[48:63], v[64:67], v[88:91], v[48:63]
ds_read_b64_tr_b16 v[80:81], v14 offset:43008
ds_read_b64_tr_b16 v[82:83], v14 offset:43776
ds_read_b64_tr_b16 v[84:85], v14 offset:43072
ds_read_b64_tr_b16 v[86:87], v14 offset:43840
ds_read_b64_tr_b16 v[88:89], v14 offset:43136
ds_read_b64_tr_b16 v[90:91], v14 offset:43904
s_waitcnt lgkmcnt(6)
v_mfma_f32_32x32x16_bf16 v[16:31], v[92:95], v[68:71], v[16:31]
v_mfma_f32_32x32x16_bf16 v[32:47], v[96:99], v[68:71], v[32:47]
v_mfma_f32_32x32x16_bf16 v[48:63], v[68:71], v[100:103], v[48:63]
ds_read_b64_tr_b16 v[92:93], v14 offset:46080
ds_read_b64_tr_b16 v[94:95], v14 offset:46848
ds_read_b64_tr_b16 v[96:97], v14 offset:46144
ds_read_b64_tr_b16 v[98:99], v14 offset:46912
ds_read_b64_tr_b16 v[100:101], v14 offset:46208
ds_read_b64_tr_b16 v[102:103], v14 offset:46976
s_waitcnt lgkmcnt(6)
v_mfma_f32_32x32x16_bf16 v[16:31], v[80:83], v[72:75], v[16:31]
v_mfma_f32_32x32x16_bf16 v[32:47], v[84:87], v[72:75], v[32:47]
v_mfma_f32_32x32x16_bf16 v[48:63], v[72:75], v[88:91], v[48:63]
s_waitcnt lgkmcnt(0)
v_mfma_f32_32x32x16_bf16 v[16:31], v[92:95], v[76:79], v[16:31]
v_mfma_f32_32x32x16_bf16 v[32:47], v[96:99], v[76:79], v[32:47]
v_mfma_f32_32x32x16_bf16 v[48:63], v[76:79], v[100:103], v[48:63]
ds_write_b128 v8, v[192:195] offset:0
ds_write_b128 v9, v[196:199] offset:1024
ds_write_b128 v8, v[200:203] offset:2048
ds_write_b128 v9, v[204:207] offset:3072
ds_read_b128 v[64:67], v10
ds_read_b128 v[68:71], v11
ds_read_b128 v[72:75], v12
ds_read_b128 v[76:79], v13
ds_read_b64_tr_b16 v[80:81], v15 offset:0
ds_read_b64_tr_b16 v[82:83], v15 offset:768
ds_read_b64_tr_b16 v[84:85], v15 offset:64
ds_read_b64_tr_b16 v[86:87], v15 offset:832
ds_read_b64_tr_b16 v[88:89], v15 offset:128
ds_read_b64_tr_b16 v[90:91], v15 offset:896
ds_read_b64_tr_b16 v[92:93], v15 offset:3072
ds_read_b64_tr_b16 v[94:95], v15 offset:3840
ds_read_b64_tr_b16 v[96:97], v15 offset:3136
ds_read_b64_tr_b16 v[98:99], v15 offset:3904
ds_read_b64_tr_b16 v[100:101], v15 offset:3200
ds_read_b64_tr_b16 v[102:103], v15 offset:3968
s_waitcnt lgkmcnt(6)
v_mfma_f32_32x32x16_bf16 v[16:31], v[80:83], v[64:67], v[16:31]
v_mfma_f32_32x32x16_bf16 v[32:47], v[84:87], v[64:67], v[32:47]
v_mfma_f32_32x32x16_bf16 v[48:63], v[64:67], v[88:91], v[48:63]
ds_read_b64_tr_b16 v[80:81], v15 offset:6144
ds_read_b64_tr_b16 v[82:83], v15 offset:6912
ds_read_b64_tr_b16 v[84:85], v15 offset:6208
ds_read_b64_tr_b16 v[86:87], v15 offset:6976
ds_read_b64_tr_b16 v[88:89], v15 offset:6272
ds_read_b64_tr_b16 v[90:91], v15 offset:7040
s_waitcnt lgkmcnt(6)
v_mfma_f32_32x32x16_bf16 v[16:31], v[92:95], v[68:71], v[16:31]
v_mfma_f32_32x32x16_bf16 v[32:47], v[96:99], v[68:71], v[32:47]
v_mfma_f32_32x32x16_bf16 v[48:63], v[68:71], v[100:103], v[48:63]
ds_read_b64_tr_b16 v[92:93], v15 offset:9216
ds_read_b64_tr_b16 v[94:95], v15 offset:9984
ds_read_b64_tr_b16 v[96:97], v15 offset:9280
ds_read_b64_tr_b16 v[98:99], v15 offset:10048
ds_read_b64_tr_b16 v[100:101], v15 offset:9344
ds_read_b64_tr_b16 v[102:103], v15 offset:10112
s_waitcnt lgkmcnt(6)
v_mfma_f32_32x32x16_bf16 v[16:31], v[80:83], v[72:75], v[16:31]
v_mfma_f32_32x32x16_bf16 v[32:47], v[84:87], v[72:75], v[32:47]
v_mfma_f32_32x32x16_bf16 v[48:63], v[72:75], v[88:91], v[48:63]
s_waitcnt lgkmcnt(0)
v_mfma_f32_32x32x16_bf16 v[16:31], v[92:95], v[76:79], v[16:31]
v_mfma_f32_32x32x16_bf16 v[32:47], v[96:99], v[76:79], v[32:47]
v_mfma_f32_32x32x16_bf16 v[48:63], v[76:79], v[100:103], v[48:63]
s_waitcnt vmcnt(0)
s_mov_b32 exec_lo, 0xffff0000
s_mov_b32 exec_hi, 0xffff
ds_write_b16 v114, v113 offset:49152
s_mov_b64 exec, -1
s_mov_b64 exec, 1
ds_add_u32 v4, v5 offset:8
s_mov_b64 exec, -1
ds_write_b128 v8, v[208:211] offset:0
ds_write_b128 v9, v[212:215] offset:1024
ds_write_b128 v8, v[216:219] offset:2048
ds_write_b128 v9, v[220:223] offset:3072
ds_read_b128 v[64:67], v10
ds_read_b128 v[68:71], v11
ds_read_b128 v[72:75], v12
ds_read_b128 v[76:79], v13
W_5:
ds_read_b32 v6, v4 offset:8
s_waitcnt lgkmcnt(0)
v_readfirstlane_b32 s39, v6
s_cmp_ge_u32 s39, 4
s_cbranch_scc1 D_6
s_sub_u32 s36, s36, 1
s_cbranch_scc0 W_5
s_mov_b32 s36, 0
D_6:
ds_read_b64_tr_b16 v[80:81], v15 offset:12288
ds_read_b64_tr_b16 v[82:83], v15 offset:13056
ds_read_b64_tr_b16 v[84:85], v15 offset:12352
ds_read_b64_tr_b16 v[86:87], v15 offset:13120
ds_read_b64_tr_b16 v[88:89], v15 offset:12416
ds_read_b64_tr_b16 v[90:91], v15 offset:13184
ds_read_b64_tr_b16 v[92:93], v15 offset:15360
ds_read_b64_tr_b16 v[94:95], v15 offset:16128
ds_read_b64_tr_b16 v[96:97], v15 offset:15424
ds_read_b64_tr_b16 v[98:99], v15 offset:16192
ds_read_b64_tr_b16 v[100:101], v15 offset:15488
ds_read_b64_tr_b16 v[102:103], v15 offset:16256
s_waitcnt lgkmcnt(6)
v_mfma_f32_32x32x16_bf16 v[16:31], v[80:83], v[64:67], v[16:31]
v_mfma_f32_32x32x16_bf16 v[32:47], v[84:87], v[64:67], v[32:47]
v_mfma_f32_32x32x16_bf16 v[48:63], v[64:67], v[88:91], v[48:63]
ds_read_b64_tr_b16 v[80:81], v15 offset:18432
ds_read_b64_tr_b16 v[82:83], v15 offset:19200
ds_read_b64_tr_b16 v[84:85], v15 offset:18496
ds_read_b64_tr_b16 v[86:87], v15 offset:19264
ds_read_b64_tr_b16 v[88:89], v15 offset:18560
ds_read_b64_tr_b16 v[90:91], v15 offset:19328
s_waitcnt lgkmcnt(6)
v_mfma_f32_32x32x16_bf16 v[16:31], v[92:95], v[68:71], v[16:31]
v_mfma_f32_32x32x16_bf16 v[32:47], v[96:99], v[68:71], v[32:47]
v_mfma_f32_32x32x16_bf16 v[48:63], v[68:71], v[100:103], v[48:63]
ds_read_b64_tr_b16 v[92:93], v15 offset:21504
ds_read_b64_tr_b16 v[94:95], v15 offset:22272
ds_read_b64_tr_b16 v[96:97], v15 offset:21568
ds_read_b64_tr_b16 v[98:99], v15 offset:22336
ds_read_b64_tr_b16 v[100:101], v15 offset:21632
ds_read_b64_tr_b16 v[102:103], v15 offset:22400
s_waitcnt lgkmcnt(6)
v_mfma_f32_32x32x16_bf16 v[16:31], v[80:83], v[72:75], v[16:31]
v_mfma_f32_32x32x16_bf16 v[32:47], v[84:87], v[72:75], v[32:47]
v_mfma_f32_32x32x16_bf16 v[48:63], v[72:75], v[88:91], v[48:63]
s_waitcnt lgkmcnt(0)
v_mfma_f32_32x32x16_bf16 v[16:31], v[92:95], v[76:79], v[16:31]
v_mfma_f32_32x32x16_bf16 v[32:47], v[96:99], v[76:79], v[32:47]
v_mfma_f32_32x32x16_bf16 v[48:63], v[76:79], v[100:103], v[48:63]
ds_write_b128 v8, v[224:227] offset:0
ds_write_b128 v9, v[228:231] offset:1024
ds_write_b128 v8, v[232:235] offset:2048
ds_write_b128 v9, v[236:239] offset:3072
ds_read_b128 v[64:67], v10
ds_read_b128 v[68:71], v11
ds_read_b128 v[72:75], v12
ds_read_b128 v[76:79], v13
ds_read_b64_tr_b16 v[80:81], v15 offset:24576
ds_read_b64_tr_b16 v[82:83], v15 offset:25344
ds_read_b64_tr_b16 v[84:85], v15 offset:24640
ds_read_b64_tr_b16 v[86:87], v15 offset:25408
ds_read_b64_tr_b16 v[88:89], v15 offset:24704
ds_read_b64_tr_b16 v[90:91], v15 offset:25472
ds_read_b64_tr_b16 v[92:93], v15 offset:27648
ds_read_b64_tr_b16 v[94:95], v15 offset:28416
ds_read_b64_tr_b16 v[96:97], v15 offset:27712
ds_read_b64_tr_b16 v[98:99], v15 offset:28480
ds_read_b64_tr_b16 v[100:101], v15 offset:27776
ds_read_b64_tr_b16 v[102:103], v15 offset:28544
s_waitcnt lgkmcnt(6)
v_mfma_f32_32x32x16_bf16 v[16:31], v[80:83], v[64:67], v[16:31]
v_mfma_f32_32x32x16_bf16 v[32:47], v[84:87], v[64:67], v[32:47]
v_mfma_f32_32x32x16_bf16 v[48:63], v[64:67], v[88:91], v[48:63]
ds_read_b64_tr_b16 v[80:81], v15 offset:30720
ds_read_b64_tr_b16 v[82:83], v15 offset:31488
ds_read_b64_tr_b16 v[84:85], v15 offset:30784
ds_read_b64_tr_b16 v[86:87], v15 offset:31552
ds_read_b64_tr_b16 v[88:89], v15 offset:30848
ds_read_b64_tr_b16 v[90:91], v15 offset:31616
s_waitcnt lgkmcnt(6)
v_mfma_f32_32x32x16_bf16 v[16:31], v[92:95], v[68:71], v[16:31]
v_mfma_f32_32x32x16_bf16 v[32:47], v[96:99], v[68:71], v[32:47]
v_mfma_f32_32x32x16_bf16 v[48:63], v[68:71], v[100:103], v[48:63]
ds_read_b64_tr_b16 v[92:93], v15 offset:33792
ds_read_b64_tr_b16 v[94:95], v15 offset:34560
ds_read_b64_tr_b16 v[96:97], v15 offset:33856
ds_read_b64_tr_b16 v[98:99], v15 offset:34624
ds_read_b64_tr_b16 v[100:101], v15 offset:33920
ds_read_b64_tr_b16 v[102:103], v15 offset:34688
s_waitcnt lgkmcnt(6)
v_mfma_f32_32x32x16_bf16 v[16:31], v[80:83], v[72:75], v[16:31]
v_mfma_f32_32x32x16_bf16 v[32:47], v[84:87], v[72:75], v[32:47]
v_mfma_f32_32x32x16_bf16 v[48:63], v[72:75], v[88:91], v[48:63]
s_waitcnt lgkmcnt(0)
v_mfma_f32_32x32x16_bf16 v[16:31], v[92:95], v[76:79], v[16:31]
v_mfma_f32_32x32x16_bf16 v[32:47], v[96:99], v[76:79], v[32:47]
v_mfma_f32_32x32x16_bf16 v[48:63], v[76:79], v[100:103], v[48:63]
s_mov_b64 exec, 1
ds_add_u32 v4, v5 offset:12
s_mov_b64 exec, -1
v_mov_b32 v104, 0
v_mov_b32 v105, 0x3f803f80
v_mov_b32 v106, 0x3f80
v_cmp_eq_u32 vcc, 28, v1
s_nop 1
v_cndmask_b32 v107, v104, v105, vcc
s_lshl_b32 s40, s53, 2
s_add_u32 s40, s40, s3
s_lshl_b32 s40, s40, 11
s_lshl_b32 s41, s52, 17
s_add_u32 s40, s40, s41
s_add_u32 s40, s40, 3145728
v_lshlrev_b32 v110, 4, v0
v_add_u32 v108, s40, v110
v_add_u32 v109, 2097152, v108
s_lshl_b32 s40, s3, 12
s_add_u32 s40, s40, 86016
v_add_u32 v112, 86016, v110
v_add_u32 v111, s40, v110
s_nop 7
v_cvt_pk_bf16_f32 v72, v32, v33
v_cvt_pk_bf16_f32 v73, v34, v35
v_cvt_pk_bf16_f32 v74, v36, v37
v_cvt_pk_bf16_f32 v75, v38, v39
v_cvt_pk_bf16_f32 v76, v40, v41
v_cvt_pk_bf16_f32 v77, v42, v43
v_cvt_pk_bf16_f32 v78, v44, v45
v_cvt_pk_bf16_f32 v79, v46, v47
v_cndmask_b32 v78, v78, v105, s[54:55]
v_cndmask_b32 v79, v79, v106, s[54:55]
global_store_dwordx4 v108, v[72:75], s[30:31] sc1
global_store_dwordx4 v108, v[76:79], s[30:31] offset:1024 sc1
v_cvt_pk_bf16_f32 v80, v48, v49
v_cvt_pk_bf16_f32 v81, v50, v51
v_cvt_pk_bf16_f32 v82, v52, v53
v_cvt_pk_bf16_f32 v83, v54, v55
v_cvt_pk_bf16_f32 v84, v56, v57
v_cvt_pk_bf16_f32 v85, v58, v59
v_cvt_pk_bf16_f32 v86, v60, v61
v_cvt_pk_bf16_f32 v87, v62, v63
v_cndmask_b32 v80, v80, v107, s[56:57]
v_cndmask_b32 v81, v81, v107, s[56:57]
v_cndmask_b32 v82, v82, v107, s[56:57]
v_cndmask_b32 v83, v83, v107, s[56:57]
v_cndmask_b32 v84, v84, v107, s[56:57]
v_cndmask_b32 v85, v85, v107, s[56:57]
v_cndmask_b32 v86, v86, v107, s[56:57]
v_cndmask_b32 v87, v87, v107, s[56:57]
global_store_dwordx4 v109, v[80:83], s[30:31] sc1
global_store_dwordx4 v109, v[84:87], s[30:31] offset:1024 sc1
s_cmp_eq_u32 s52, s53
s_cbranch_scc0 g_7
s_lshl_b32 s40, s53, 9
s_lshl_b32 s41, s3, 7
s_add_u32 s40, s40, s41
s_add_u32 s40, s40, 15728640
v_lshl_add_u32 v6, v1, 2, s40
s_mov_b32 exec_lo, 0
global_store_dword v6, v28, s[30:31] sc1
s_mov_b32 exec_lo, -1
s_nop 0
g_7:
v_mul_f32 v16, 0x3e8b97f6, v16
v_mul_f32 v17, 0x3e8b97f6, v17
v_mul_f32 v18, 0x3e8b97f6, v18
v_mul_f32 v19, 0x3e8b97f6, v19
v_mul_f32 v20, 0x3e8b97f6, v20
v_mul_f32 v21, 0x3e8b97f6, v21
v_mul_f32 v22, 0x3e8b97f6, v22
v_mul_f32 v23, 0x3e8b97f6, v23
v_mul_f32 v24, 0x3e8b97f6, v24
v_mul_f32 v25, 0x3e8b97f6, v25
v_mul_f32 v26, 0x3e8b97f6, v26
v_mul_f32 v27, 0x3e8b97f6, v27
v_mul_f32 v28, 0x3e8b97f6, v28
v_mul_f32 v29, 0x3e8b97f6, v29
v_mul_f32 v30, 0x3e8b97f6, v30
v_mul_f32 v31, 0x3e8b97f6, v31
v_cvt_pk_bf16_f32 v64, v16, v17
v_cvt_pk_bf16_f32 v65, v18, v19
v_cvt_pk_bf16_f32 v66, v20, v21
v_cvt_pk_bf16_f32 v67, v22, v23
v_cvt_pk_bf16_f32 v68, v24, v25
v_cvt_pk_bf16_f32 v69, v26, v27
v_cvt_pk_bf16_f32 v70, v28, v29
v_cvt_pk_bf16_f32 v71, v30, v31
v_cndmask_b32 v70, v70, v104, s[54:55]
v_cndmask_b32 v71, v71, v104, s[54:55]
ds_write_b128 v111, v[64:67]
ds_write_b128 v111, v[68:71] offset:1024
s_waitcnt lgkmcnt(0)
s_mov_b64 exec, 1
ds_add_u32 v4, v5 offset:0
s_mov_b64 exec, -1
v_readfirstlane_b32 s37, v3
s_mul_i32 s37, s37, 1664525
s_add_u32 s37, s37, 1013904223
s_mul_i32 s38, s37, 0x2545F491
s_xor_b32 s38, s38, 0x5bd1e995
W_8:
ds_read_b32 v6, v4 offset:0
s_waitcnt lgkmcnt(0)
v_readfirstlane_b32 s39, v6
s_cmp_ge_u32 s39, 8
s_cbranch_scc1 D_9
s_sub_u32 s36, s36, 1
s_cbranch_scc0 W_8
s_mov_b32 s36, 0
D_9:
ds_read_b128 v[16:19], v112 offset:0
ds_read_b128 v[20:23], v112 offset:1024
ds_read_b128 v[24:27], v112 offset:4096
ds_read_b128 v[28:31], v112 offset:5120
ds_read_b128 v[32:35], v112 offset:8192
ds_read_b128 v[36:39], v112 offset:9216
ds_read_b128 v[40:43], v112 offset:12288
ds_read_b128 v[44:47], v112 offset:13312
s_waitcnt vmcnt(0) lgkmcnt(0)
s_mov_b64 exec, 1
ds_add_rtn_u32 v6, v4, v5 offset:16
s_mov_b64 exec, -1
s_waitcnt lgkmcnt(0)
v_readfirstlane_b32 s39, v6
s_cmp_eq_u32 s39, 3
s_cbranch_scc0 sk_10
W_11:
ds_read_b32 v6, v4 offset:24
s_waitcnt lgkmcnt(0)
v_readfirstlane_b32 s39, v6
s_cmp_ge_u32 s39, 4
s_cbranch_scc1 D_12
s_sub_u32 s36, s36, 1
s_cbranch_scc0 W_11
s_mov_b32 s36, 0
D_12:
s_lshl_b32 s40, s52, 7
s_lshl_b32 s41, s53, 3
s_add_u32 s40, s40, s41
s_add_u32 s40, s40, 4096
v_mov_b32 v6, s40
v_mov_b32 v8, s37
v_mov_b32 v9, s38
s_mov_b64 exec, 1
global_store_dwordx2 v6, v[8:9], s[30:31] sc1
s_mov_b64 exec, -1
sk_10:
s_mov_b32 s58, 0
s_mov_b32 s59, 4
s_lshl_b32 s40, s52, 7
s_add_u32 s40, s40, 4096
v_and_b32 v6, 3, v0
v_lshl_add_u32 v6, v6, 5, s40
s_lshl_b32 s41, s3, 5
s_add_u32 s64, s40, s41
s_add_u32 s64, s64, 8
s_add_u32 s65, s64, 16
s_lshl_b32 s40, s52, 17
s_add_u32 s40, s40, 1048576
v_lshlrev_b32 v7, 4, v0
s_lshl_b32 s41, s3, 15
s_add_u32 s41, s41, s40
s_add_u32 s61, s41, 2097152
v_mov_b32 v48, 0
v_mov_b32 v49, 0
v_mov_b32 v50, 0
v_mov_b32 v51, 0
v_mov_b32 v52, 0
v_mov_b32 v53, 0
v_mov_b32 v54, 0
v_mov_b32 v55, 0
v_mov_b32 v56, 0
v_mov_b32 v57, 0
v_mov_b32 v58, 0
v_mov_b32 v59, 0
v_mov_b32 v60, 0
v_mov_b32 v61, 0
v_mov_b32 v62, 0
v_mov_b32 v63, 0
v_mov_b32 v64, 0
v_mov_b32 v65, 0
v_mov_b32 v66, 0
v_mov_b32 v67, 0
v_mov_b32 v68, 0
v_mov_b32 v69, 0
v_mov_b32 v70, 0
v_mov_b32 v71, 0
v_mov_b32 v72, 0
v_mov_b32 v73, 0
v_mov_b32 v74, 0
v_mov_b32 v75, 0
v_mov_b32 v76, 0
v_mov_b32 v77, 0
v_mov_b32 v78, 0
v_mov_b32 v79, 0
v_mov_b32 v80, 0
v_mov_b32 v81, 0
v_mov_b32 v82, 0
v_mov_b32 v83, 0
v_mov_b32 v84, 0
v_mov_b32 v85, 0
v_mov_b32 v86, 0
v_mov_b32 v87, 0
v_mov_b32 v88, 0
v_mov_b32 v89, 0
v_mov_b32 v90, 0
v_mov_b32 v91, 0
v_mov_b32 v92, 0
v_mov_b32 v93, 0
v_mov_b32 v94, 0
v_mov_b32 v95, 0
v_mov_b32 v96, 0
v_mov_b32 v97, 0
v_mov_b32 v98, 0
v_mov_b32 v99, 0
v_mov_b32 v100, 0
v_mov_b32 v101, 0
v_mov_b32 v102, 0
v_mov_b32 v103, 0
v_mov_b32 v104, 0
v_mov_b32 v105, 0
v_mov_b32 v106, 0
v_mov_b32 v107, 0
v_mov_b32 v108, 0
v_mov_b32 v109, 0
v_mov_b32 v110, 0
v_mov_b32 v111, 0
s_cmp_eq_u32 s3, 0
s_cbranch_scc0 po_13
P_15:
global_load_dwordx2 v[224:225], v6, s[30:31] sc1
s_waitcnt vmcnt(0)
v_cmp_ne_u32 vcc, s37, v224
v_cmp_ne_u32 s[50:51], s38, v225
s_or_b64 vcc, vcc, s[50:51]
s_cbranch_vccz D_16
s_sleep 2
s_sub_u32 s36, s36, 1
s_cbranch_scc0 P_15
s_mov_b32 s36, 0
D_16:
s_mov_b64 exec, 1
ds_add_u32 v4, v5 offset:60
s_mov_b64 exec, -1
s_branch pd_14
po_13:
W_17:
ds_read_b32 v224, v4 offset:60
s_waitcnt lgkmcnt(0)
v_readfirstlane_b32 s39, v224
s_cmp_ge_u32 s39, 1
s_cbranch_scc1 D_18
s_sleep 1
s_sub_u32 s36, s36, 1
s_cbranch_scc0 W_17
s_mov_b32 s36, 0
D_18:
pd_14:
s_setprio 3
RERUN:
v_lshlrev_b32 v7, 4, v0
v_add_u32 v8, s61, v7
v_add_u32 v10, 30720, v8
v_mov_b32 v11, s64
global_load_dwordx2 v[224:225], v11, s[30:31] sc1
v_add_u32 v9, 2097152, v8
global_load_dwordx4 v[160:163], v8, s[30:31] sc1
global_load_dwordx4 v[164:167], v8, s[30:31] offset:1024 sc1
global_load_dwordx4 v[168:171], v9, s[30:31] sc1
global_load_dwordx4 v[172:175], v9, s[30:31] offset:1024 sc1
v_add_u32 v8, 2048, v8
v_min_u32 v8, v8, v10
v_add_u32 v9, 2097152, v8
global_load_dwordx4 v[176:179], v8, s[30:31] sc1
global_load_dwordx4 v[180:183], v8, s[30:31] offset:1024 sc1
global_load_dwordx4 v[184:187], v9, s[30:31] sc1
global_load_dwordx4 v[188:191], v9, s[30:31] offset:1024 sc1
v_add_u32 v8, 2048, v8
v_min_u32 v8, v8, v10
v_add_u32 v9, 2097152, v8
global_load_dwordx4 v[192:195], v8, s[30:31] sc1
global_load_dwordx4 v[196:199], v8, s[30:31] offset:1024 sc1
global_load_dwordx4 v[200:203], v9, s[30:31] sc1
global_load_dwordx4 v[204:207], v9, s[30:31] offset:1024 sc1
v_add_u32 v8, 2048, v8
v_min_u32 v8, v8, v10
v_mov_b32 v216, 0
v_mov_b32 v152, 0
v_mov_b32 v217, 0
v_mov_b32 v153, 0
v_mov_b32 v218, 0
v_mov_b32 v154, 0
v_mov_b32 v219, 0
v_mov_b32 v155, 0
v_mov_b32 v220, 0
v_mov_b32 v156, 0
v_mov_b32 v221, 0
v_mov_b32 v157, 0
v_mov_b32 v222, 0
v_mov_b32 v158, 0
v_mov_b32 v223, 0
v_mov_b32 v159, 0
s_waitcnt vmcnt(8)
v_mfma_f32_32x32x16_bf16 v[112:127], v[160:163], v[16:19], 0
v_mfma_f32_32x32x16_bf16 v[112:127], v[164:167], v[20:23], v[112:127]
s_nop 7
s_nop 7
s_mov_b32 s60, 4
s_mov_b32 s49, 0x07060302
ALOOP:
v_mfma_f32_32x32x16_bf16 v[128:143], v[160:163], v[24:27], 0
v_exp_f32 v112, v112
v_exp_f32 v113, v113
v_exp_f32 v114, v114
v_exp_f32 v115, v115
v_cvt_pk_bf16_f32 v144, v112, v113
v_mfma_f32_32x32x16_bf16 v[96:111], v[216:219], v[152:155], v[96:111]
v_exp_f32 v116, v116
v_exp_f32 v117, v117
v_cvt_pk_bf16_f32 v145, v114, v115
v_exp_f32 v118, v118
v_exp_f32 v119, v119
v_cvt_pk_bf16_f32 v146, v116, v117
v_mfma_f32_32x32x16_bf16 v[128:143], v[164:167], v[28:31], v[128:143]
v_exp_f32 v120, v120
v_exp_f32 v121, v121
v_cvt_pk_bf16_f32 v147, v118, v119
v_exp_f32 v122, v122
v_exp_f32 v123, v123
v_cvt_pk_bf16_f32 v148, v120, v121
v_mfma_f32_32x32x16_bf16 v[96:111], v[220:223], v[156:159], v[96:111]
v_exp_f32 v124, v124
v_exp_f32 v125, v125
v_cvt_pk_bf16_f32 v149, v122, v123
v_exp_f32 v126, v126
v_exp_f32 v127, v127
v_cvt_pk_bf16_f32 v150, v124, v125
s_nop 0
v_cvt_pk_bf16_f32 v151, v126, v127
v_add_u32 v9, 2097152, v8
global_load_dwordx4 v[208:211], v8, s[30:31] sc1
global_load_dwordx4 v[212:215], v8, s[30:31] offset:1024 sc1
global_load_dwordx4 v[216:219], v9, s[30:31] sc1
global_load_dwordx4 v[220:223], v9, s[30:31] offset:1024 sc1
v_add_u32 v8, 2048, v8
v_min_u32 v8, v8, v10
v_mfma_f32_32x32x16_bf16 v[112:127], v[160:163], v[32:35], 0
v_exp_f32 v128, v128
v_exp_f32 v129, v129
v_exp_f32 v130, v130
v_exp_f32 v131, v131
v_cvt_pk_bf16_f32 v152, v128, v129
v_mfma_f32_32x32x16_bf16 v[48:63], v[168:171], v[144:147], v[48:63]
v_exp_f32 v132, v132
v_exp_f32 v133, v133
v_cvt_pk_bf16_f32 v153, v130, v131
v_exp_f32 v134, v134
v_exp_f32 v135, v135
v_cvt_pk_bf16_f32 v154, v132, v133
v_mfma_f32_32x32x16_bf16 v[112:127], v[164:167], v[36:39], v[112:127]
v_exp_f32 v136, v136
v_exp_f32 v137, v137
v_cvt_pk_bf16_f32 v155, v134, v135
v_exp_f32 v138, v138
v_exp_f32 v139, v139
v_cvt_pk_bf16_f32 v156, v136, v137
v_mfma_f32_32x32x16_bf16 v[48:63], v[172:175], v[148:151], v[48:63]
v_exp_f32 v140, v140
v_exp_f32 v141, v141
v_cvt_pk_bf16_f32 v157, v138, v139
v_exp_f32 v142, v142
v_exp_f32 v143, v143
v_cvt_pk_bf16_f32 v158, v140, v141
s_nop 0
v_cvt_pk_bf16_f32 v159, v142, v143
v_mfma_f32_32x32x16_bf16 v[128:143], v[160:163], v[40:43], 0
v_exp_f32 v112, v112
v_exp_f32 v113, v113
v_exp_f32 v114, v114
v_exp_f32 v115, v115
v_cvt_pk_bf16_f32 v144, v112, v113
v_mfma_f32_32x32x16_bf16 v[64:79], v[168:171], v[152:155], v[64:79]
v_exp_f32 v116, v116
v_exp_f32 v117, v117
v_cvt_pk_bf16_f32 v145, v114, v115
v_exp_f32 v118, v118
v_exp_f32 v119, v119
v_cvt_pk_bf16_f32 v146, v116, v117
v_mfma_f32_32x32x16_bf16 v[128:143], v[164:167], v[44:47], v[128:143]
v_exp_f32 v120, v120
v_exp_f32 v121, v121
v_cvt_pk_bf16_f32 v147, v118, v119
v_exp_f32 v122, v122
v_exp_f32 v123, v123
v_cvt_pk_bf16_f32 v148, v120, v121
v_mfma_f32_32x32x16_bf16 v[64:79], v[172:175], v[156:159], v[64:79]
v_exp_f32 v124, v124
v_exp_f32 v125, v125
v_cvt_pk_bf16_f32 v149, v122, v123
v_exp_f32 v126, v126
v_exp_f32 v127, v127
v_cvt_pk_bf16_f32 v150, v124, v125
s_nop 0
v_cvt_pk_bf16_f32 v151, v126, v127
s_waitcnt vmcnt(8)
v_mfma_f32_32x32x16_bf16 v[112:127], v[176:179], v[16:19], 0
v_exp_f32 v128, v128
v_exp_f32 v129, v129
v_exp_f32 v130, v130
v_exp_f32 v131, v131
v_cvt_pk_bf16_f32 v152, v128, v129
v_mfma_f32_32x32x16_bf16 v[80:95], v[168:171], v[144:147], v[80:95]
v_exp_f32 v132, v132
v_exp_f32 v133, v133
v_cvt_pk_bf16_f32 v153, v130, v131
v_exp_f32 v134, v134
v_exp_f32 v135, v135
v_cvt_pk_bf16_f32 v154, v132, v133
v_mfma_f32_32x32x16_bf16 v[112:127], v[180:183], v[20:23], v[112:127]
v_exp_f32 v136, v136
v_exp_f32 v137, v137
v_cvt_pk_bf16_f32 v155, v134, v135
v_exp_f32 v138, v138
v_exp_f32 v139, v139
v_cvt_pk_bf16_f32 v156, v136, v137
v_mfma_f32_32x32x16_bf16 v[80:95], v[172:175], v[148:151], v[80:95]
v_exp_f32 v140, v140
v_exp_f32 v141, v141
v_cvt_pk_bf16_f32 v157, v138, v139
v_exp_f32 v142, v142
v_exp_f32 v143, v143
v_cvt_pk_bf16_f32 v158, v140, v141
s_nop 0
v_cvt_pk_bf16_f32 v159, v142, v143
v_mfma_f32_32x32x16_bf16 v[128:143], v[176:179], v[24:27], 0
v_exp_f32 v112, v112
v_exp_f32 v113, v113
v_exp_f32 v114, v114
v_exp_f32 v115, v115
v_cvt_pk_bf16_f32 v144, v112, v113
v_mfma_f32_32x32x16_bf16 v[96:111], v[168:171], v[152:155], v[96:111]
v_exp_f32 v116, v116
v_exp_f32 v117, v117
v_cvt_pk_bf16_f32 v145, v114, v115
v_exp_f32 v118, v118
v_exp_f32 v119, v119
v_cvt_pk_bf16_f32 v146, v116, v117
v_mfma_f32_32x32x16_bf16 v[128:143], v[180:183], v[28:31], v[128:143]
v_exp_f32 v120, v120
v_exp_f32 v121, v121
v_cvt_pk_bf16_f32 v147, v118, v119
v_exp_f32 v122, v122
v_exp_f32 v123, v123
v_cvt_pk_bf16_f32 v148, v120, v121
v_mfma_f32_32x32x16_bf16 v[96:111], v[172:175], v[156:159], v[96:111]
v_exp_f32 v124, v124
v_exp_f32 v125, v125
v_cvt_pk_bf16_f32 v149, v122, v123
v_exp_f32 v126, v126
v_exp_f32 v127, v127
v_cvt_pk_bf16_f32 v150, v124, v125
s_nop 0
v_cvt_pk_bf16_f32 v151, v126, v127
v_cmp_ne_u32 vcc, s37, v224
v_cmp_ne_u32 s[50:51], s38, v225
s_or_b64 vcc, vcc, s[50:51]
s_cbranch_vccz fk_19
P_20:
global_load_dwordx2 v[224:225], v11, s[30:31] sc1
s_waitcnt vmcnt(0)
v_cmp_ne_u32 vcc, s37, v224
v_cmp_ne_u32 s[50:51], s38, v225
s_or_b64 vcc, vcc, s[50:51]
s_cbranch_vccz D_21
s_sleep 2
s_sub_u32 s36, s36, 1
s_cbranch_scc0 P_20
s_mov_b32 s36, 0
D_21:
fk_19:
v_add_u32 v9, 2097152, v8
global_load_dwordx4 v[160:163], v8, s[30:31] sc1
global_load_dwordx4 v[164:167], v8, s[30:31] offset:1024 sc1
global_load_dwordx4 v[168:171], v9, s[30:31] sc1
global_load_dwordx4 v[172:175], v9, s[30:31] offset:1024 sc1
v_add_u32 v8, 2048, v8
v_min_u32 v8, v8, v10
v_mfma_f32_32x32x16_bf16 v[112:127], v[176:179], v[32:35], 0
v_exp_f32 v128, v128
v_exp_f32 v129, v129
v_exp_f32 v130, v130
v_exp_f32 v131, v131
v_cvt_pk_bf16_f32 v152, v128, v129
v_mfma_f32_32x32x16_bf16 v[48:63], v[184:187], v[144:147], v[48:63]
v_exp_f32 v132, v132
v_exp_f32 v133, v133
v_cvt_pk_bf16_f32 v153, v130, v131
v_exp_f32 v134, v134
v_exp_f32 v135, v135
v_cvt_pk_bf16_f32 v154, v132, v133
v_mfma_f32_32x32x16_bf16 v[112:127], v[180:183], v[36:39], v[112:127]
v_exp_f32 v136, v136
v_exp_f32 v137, v137
v_cvt_pk_bf16_f32 v155, v134, v135
v_exp_f32 v138, v138
v_exp_f32 v139, v139
v_cvt_pk_bf16_f32 v156, v136, v137
v_mfma_f32_32x32x16_bf16 v[48:63], v[188:191], v[148:151], v[48:63]
v_exp_f32 v140, v140
v_exp_f32 v141, v141
v_cvt_pk_bf16_f32 v157, v138, v139
v_exp_f32 v142, v142
v_exp_f32 v143, v143
v_cvt_pk_bf16_f32 v158, v140, v141
s_nop 0
v_cvt_pk_bf16_f32 v159, v142, v143
v_mfma_f32_32x32x16_bf16 v[128:143], v[176:179], v[40:43], 0
v_exp_f32 v112, v112
v_exp_f32 v113, v113
v_exp_f32 v114, v114
v_exp_f32 v115, v115
v_cvt_pk_bf16_f32 v144, v112, v113
v_mfma_f32_32x32x16_bf16 v[64:79], v[184:187], v[152:155], v[64:79]
v_exp_f32 v116, v116
v_exp_f32 v117, v117
v_cvt_pk_bf16_f32 v145, v114, v115
v_exp_f32 v118, v118
v_exp_f32 v119, v119
v_cvt_pk_bf16_f32 v146, v116, v117
v_mfma_f32_32x32x16_bf16 v[128:143], v[180:183], v[44:47], v[128:143]
v_exp_f32 v120, v120
v_exp_f32 v121, v121
v_cvt_pk_bf16_f32 v147, v118, v119
v_exp_f32 v122, v122
v_exp_f32 v123, v123
v_cvt_pk_bf16_f32 v148, v120, v121
v_mfma_f32_32x32x16_bf16 v[64:79], v[188:191], v[156:159], v[64:79]
v_exp_f32 v124, v124
v_exp_f32 v125, v125
v_cvt_pk_bf16_f32 v149, v122, v123
v_exp_f32 v126, v126
v_exp_f32 v127, v127
v_cvt_pk_bf16_f32 v150, v124, v125
s_nop 0
v_cvt_pk_bf16_f32 v151, v126, v127
s_waitcnt vmcnt(8)
v_mfma_f32_32x32x16_bf16 v[112:127], v[192:195], v[16:19], 0
v_exp_f32 v128, v128
v_exp_f32 v129, v129
v_exp_f32 v130, v130
v_exp_f32 v131, v131
v_cvt_pk_bf16_f32 v152, v128, v129
v_mfma_f32_32x32x16_bf16 v[80:95], v[184:187], v[144:147], v[80:95]
v_exp_f32 v132, v132
v_exp_f32 v133, v133
v_cvt_pk_bf16_f32 v153, v130, v131
v_exp_f32 v134, v134
v_exp_f32 v135, v135
v_cvt_pk_bf16_f32 v154, v132, v133
v_mfma_f32_32x32x16_bf16 v[112:127], v[196:199], v[20:23], v[112:127]
v_exp_f32 v136, v136
v_exp_f32 v137, v137
v_cvt_pk_bf16_f32 v155, v134, v135
v_exp_f32 v138, v138
v_exp_f32 v139, v139
v_cvt_pk_bf16_f32 v156, v136, v137
v_mfma_f32_32x32x16_bf16 v[80:95], v[188:191], v[148:151], v[80:95]
v_exp_f32 v140, v140
v_exp_f32 v141, v141
v_cvt_pk_bf16_f32 v157, v138, v139
v_exp_f32 v142, v142
v_exp_f32 v143, v143
v_cvt_pk_bf16_f32 v158, v140, v141
s_nop 0
v_cvt_pk_bf16_f32 v159, v142, v143
v_mfma_f32_32x32x16_bf16 v[128:143], v[192:195], v[24:27], 0
v_exp_f32 v112, v112
v_exp_f32 v113, v113
v_exp_f32 v114, v114
v_exp_f32 v115, v115
v_cvt_pk_bf16_f32 v144, v112, v113
v_mfma_f32_32x32x16_bf16 v[96:111], v[184:187], v[152:155], v[96:111]
v_exp_f32 v116, v116
v_exp_f32 v117, v117
v_cvt_pk_bf16_f32 v145, v114, v115
v_exp_f32 v118, v118
v_exp_f32 v119, v119
v_cvt_pk_bf16_f32 v146, v116, v117
v_mfma_f32_32x32x16_bf16 v[128:143], v[196:199], v[28:31], v[128:143]
v_exp_f32 v120, v120
v_exp_f32 v121, v121
v_cvt_pk_bf16_f32 v147, v118, v119
v_exp_f32 v122, v122
v_exp_f32 v123, v123
v_cvt_pk_bf16_f32 v148, v120, v121
v_mfma_f32_32x32x16_bf16 v[96:111], v[188:191], v[156:159], v[96:111]
v_exp_f32 v124, v124
v_exp_f32 v125, v125
v_cvt_pk_bf16_f32 v149, v122, v123
v_exp_f32 v126, v126
v_exp_f32 v127, v127
v_cvt_pk_bf16_f32 v150, v124, v125
s_nop 0
v_cvt_pk_bf16_f32 v151, v126, v127
v_add_u32 v9, 2097152, v8
global_load_dwordx4 v[176:179], v8, s[30:31] sc1
global_load_dwordx4 v[180:183], v8, s[30:31] offset:1024 sc1
global_load_dwordx4 v[184:187], v9, s[30:31] sc1
global_load_dwordx4 v[188:191], v9, s[30:31] offset:1024 sc1
v_add_u32 v8, 2048, v8
v_min_u32 v8, v8, v10
v_mfma_f32_32x32x16_bf16 v[112:127], v[192:195], v[32:35], 0
v_exp_f32 v128, v128
v_exp_f32 v129, v129
v_exp_f32 v130, v130
v_exp_f32 v131, v131
v_cvt_pk_bf16_f32 v152, v128, v129
v_mfma_f32_32x32x16_bf16 v[48:63], v[200:203], v[144:147], v[48:63]
v_exp_f32 v132, v132
v_exp_f32 v133, v133
v_cvt_pk_bf16_f32 v153, v130, v131
v_exp_f32 v134, v134
v_exp_f32 v135, v135
v_cvt_pk_bf16_f32 v154, v132, v133
v_mfma_f32_32x32x16_bf16 v[112:127], v[196:199], v[36:39], v[112:127]
v_exp_f32 v136, v136
v_exp_f32 v137, v137
v_cvt_pk_bf16_f32 v155, v134, v135
v_exp_f32 v138, v138
v_exp_f32 v139, v139
v_cvt_pk_bf16_f32 v156, v136, v137
v_mfma_f32_32x32x16_bf16 v[48:63], v[204:207], v[148:151], v[48:63]
v_exp_f32 v140, v140
v_exp_f32 v141, v141
v_cvt_pk_bf16_f32 v157, v138, v139
v_exp_f32 v142, v142
v_exp_f32 v143, v143
v_cvt_pk_bf16_f32 v158, v140, v141
s_nop 0
v_cvt_pk_bf16_f32 v159, v142, v143
v_mfma_f32_32x32x16_bf16 v[128:143], v[192:195], v[40:43], 0
v_exp_f32 v112, v112
v_exp_f32 v113, v113
v_exp_f32 v114, v114
v_exp_f32 v115, v115
v_cvt_pk_bf16_f32 v144, v112, v113
v_mfma_f32_32x32x16_bf16 v[64:79], v[200:203], v[152:155], v[64:79]
v_exp_f32 v116, v116
v_exp_f32 v117, v117
v_cvt_pk_bf16_f32 v145, v114, v115
v_exp_f32 v118, v118
v_exp_f32 v119, v119
v_cvt_pk_bf16_f32 v146, v116, v117
v_mfma_f32_32x32x16_bf16 v[128:143], v[196:199], v[44:47], v[128:143]
v_exp_f32 v120, v120
v_exp_f32 v121, v121
v_cvt_pk_bf16_f32 v147, v118, v119
v_exp_f32 v122, v122
v_exp_f32 v123, v123
v_cvt_pk_bf16_f32 v148, v120, v121
v_mfma_f32_32x32x16_bf16 v[64:79], v[204:207], v[156:159], v[64:79]
v_exp_f32 v124, v124
v_exp_f32 v125, v125
v_cvt_pk_bf16_f32 v149, v122, v123
v_exp_f32 v126, v126
v_exp_f32 v127, v127
v_cvt_pk_bf16_f32 v150, v124, v125
s_nop 0
v_cvt_pk_bf16_f32 v151, v126, v127
s_waitcnt vmcnt(8)
v_mfma_f32_32x32x16_bf16 v[112:127], v[208:211], v[16:19], 0
v_exp_f32 v128, v128
v_exp_f32 v129, v129
v_exp_f32 v130, v130
v_exp_f32 v131, v131
v_cvt_pk_bf16_f32 v152, v128, v129
v_mfma_f32_32x32x16_bf16 v[80:95], v[200:203], v[144:147], v[80:95]
v_exp_f32 v132, v132
v_exp_f32 v133, v133
v_cvt_pk_bf16_f32 v153, v130, v131
v_exp_f32 v134, v134
v_exp_f32 v135, v135
v_cvt_pk_bf16_f32 v154, v132, v133
v_mfma_f32_32x32x16_bf16 v[112:127], v[212:215], v[20:23], v[112:127]
v_exp_f32 v136, v136
v_exp_f32 v137, v137
v_cvt_pk_bf16_f32 v155, v134, v135
v_exp_f32 v138, v138
v_exp_f32 v139, v139
v_cvt_pk_bf16_f32 v156, v136, v137
v_mfma_f32_32x32x16_bf16 v[80:95], v[204:207], v[148:151], v[80:95]
v_exp_f32 v140, v140
v_exp_f32 v141, v141
v_cvt_pk_bf16_f32 v157, v138, v139
v_exp_f32 v142, v142
v_exp_f32 v143, v143
v_cvt_pk_bf16_f32 v158, v140, v141
s_nop 0
v_cvt_pk_bf16_f32 v159, v142, v143
v_mfma_f32_32x32x16_bf16 v[128:143], v[208:211], v[24:27], 0
v_exp_f32 v112, v112
v_exp_f32 v113, v113
v_exp_f32 v114, v114
v_exp_f32 v115, v115
v_cvt_pk_bf16_f32 v144, v112, v113
v_mfma_f32_32x32x16_bf16 v[96:111], v[200:203], v[152:155], v[96:111]
v_exp_f32 v116, v116
v_exp_f32 v117, v117
v_cvt_pk_bf16_f32 v145, v114, v115
v_exp_f32 v118, v118
v_exp_f32 v119, v119
v_cvt_pk_bf16_f32 v146, v116, v117
v_mfma_f32_32x32x16_bf16 v[128:143], v[212:215], v[28:31], v[128:143]
v_exp_f32 v120, v120
v_exp_f32 v121, v121
v_cvt_pk_bf16_f32 v147, v118, v119
v_exp_f32 v122, v122
v_exp_f32 v123, v123
v_cvt_pk_bf16_f32 v148, v120, v121
v_mfma_f32_32x32x16_bf16 v[96:111], v[204:207], v[156:159], v[96:111]
v_exp_f32 v124, v124
v_exp_f32 v125, v125
v_cvt_pk_bf16_f32 v149, v122, v123
v_exp_f32 v126, v126
v_exp_f32 v127, v127
v_cvt_pk_bf16_f32 v150, v124, v125
s_nop 0
v_cvt_pk_bf16_f32 v151, v126, v127
v_add_u32 v11, 8, v11
v_min_u32 v11, s65, v11
global_load_dwordx2 v[224:225], v11, s[30:31] sc1
v_add_u32 v9, 2097152, v8
global_load_dwordx4 v[192:195], v8, s[30:31] sc1
global_load_dwordx4 v[196:199], v8, s[30:31] offset:1024 sc1
global_load_dwordx4 v[200:203], v9, s[30:31] sc1
global_load_dwordx4 v[204:207], v9, s[30:31] offset:1024 sc1
v_add_u32 v8, 2048, v8
v_min_u32 v8, v8, v10
v_mfma_f32_32x32x16_bf16 v[112:127], v[208:211], v[32:35], 0
v_exp_f32 v128, v128
v_exp_f32 v129, v129
v_exp_f32 v130, v130
v_exp_f32 v131, v131
v_cvt_pk_bf16_f32 v152, v128, v129
v_mfma_f32_32x32x16_bf16 v[48:63], v[216:219], v[144:147], v[48:63]
v_exp_f32 v132, v132
v_exp_f32 v133, v133
v_cvt_pk_bf16_f32 v153, v130, v131
v_exp_f32 v134, v134
v_exp_f32 v135, v135
v_cvt_pk_bf16_f32 v154, v132, v133
v_mfma_f32_32x32x16_bf16 v[112:127], v[212:215], v[36:39], v[112:127]
v_exp_f32 v136, v136
v_exp_f32 v137, v137
v_cvt_pk_bf16_f32 v155, v134, v135
v_exp_f32 v138, v138
v_exp_f32 v139, v139
v_cvt_pk_bf16_f32 v156, v136, v137
v_mfma_f32_32x32x16_bf16 v[48:63], v[220:223], v[148:151], v[48:63]
v_exp_f32 v140, v140
v_exp_f32 v141, v141
v_cvt_pk_bf16_f32 v157, v138, v139
v_exp_f32 v142, v142
v_exp_f32 v143, v143
v_cvt_pk_bf16_f32 v158, v140, v141
s_nop 0
v_cvt_pk_bf16_f32 v159, v142, v143
v_mfma_f32_32x32x16_bf16 v[128:143], v[208:211], v[40:43], 0
v_exp_f32 v112, v112
v_exp_f32 v113, v113
v_exp_f32 v114, v114
v_exp_f32 v115, v115
v_cvt_pk_bf16_f32 v144, v112, v113
v_mfma_f32_32x32x16_bf16 v[64:79], v[216:219], v[152:155], v[64:79]
v_exp_f32 v116, v116
v_exp_f32 v117, v117
v_cvt_pk_bf16_f32 v145, v114, v115
v_exp_f32 v118, v118
v_exp_f32 v119, v119
v_cvt_pk_bf16_f32 v146, v116, v117
v_mfma_f32_32x32x16_bf16 v[128:143], v[212:215], v[44:47], v[128:143]
v_exp_f32 v120, v120
v_exp_f32 v121, v121
v_cvt_pk_bf16_f32 v147, v118, v119
v_exp_f32 v122, v122
v_exp_f32 v123, v123
v_cvt_pk_bf16_f32 v148, v120, v121
v_mfma_f32_32x32x16_bf16 v[64:79], v[220:223], v[156:159], v[64:79]
v_exp_f32 v124, v124
v_exp_f32 v125, v125
v_cvt_pk_bf16_f32 v149, v122, v123
v_exp_f32 v126, v126
v_exp_f32 v127, v127
v_cvt_pk_bf16_f32 v150, v124, v125
s_nop 0
v_cvt_pk_bf16_f32 v151, v126, v127
s_waitcnt vmcnt(8)
v_mfma_f32_32x32x16_bf16 v[112:127], v[160:163], v[16:19], 0
v_exp_f32 v128, v128
v_exp_f32 v129, v129
v_exp_f32 v130, v130
v_exp_f32 v131, v131
v_cvt_pk_bf16_f32 v152, v128, v129
v_mfma_f32_32x32x16_bf16 v[80:95], v[216:219], v[144:147], v[80:95]
v_exp_f32 v132, v132
v_exp_f32 v133, v133
v_cvt_pk_bf16_f32 v153, v130, v131
v_exp_f32 v134, v134
v_exp_f32 v135, v135
v_cvt_pk_bf16_f32 v154, v132, v133
v_mfma_f32_32x32x16_bf16 v[112:127], v[164:167], v[20:23], v[112:127]
v_exp_f32 v136, v136
v_exp_f32 v137, v137
v_cvt_pk_bf16_f32 v155, v134, v135
v_exp_f32 v138, v138
v_exp_f32 v139, v139
v_cvt_pk_bf16_f32 v156, v136, v137
v_mfma_f32_32x32x16_bf16 v[80:95], v[220:223], v[148:151], v[80:95]
v_exp_f32 v140, v140
v_exp_f32 v141, v141
v_cvt_pk_bf16_f32 v157, v138, v139
v_exp_f32 v142, v142
v_exp_f32 v143, v143
v_cvt_pk_bf16_f32 v158, v140, v141
s_nop 0
v_cvt_pk_bf16_f32 v159, v142, v143
s_sub_u32 s60, s60, 1
s_cmp_lg_u32 s60, 0
s_cbranch_scc1 ALOOP
v_mfma_f32_32x32x16_bf16 v[96:111], v[216:219], v[152:155], v[96:111]
v_mfma_f32_32x32x16_bf16 v[96:111], v[220:223], v[156:159], v[96:111]
s_waitcnt vmcnt(0)
s_setprio 3
s_lshl_b32 s40, s3, 12
v_lshlrev_b32 v7, 4, v0
v_add_u32 v6, s40, v7
s_lshl_b32 s41, s3, 14
v_add_u32 v11, s41, v7
s_nop 7
W_22:
ds_read_b32 v12, v4 offset:56
s_waitcnt lgkmcnt(0)
v_readfirstlane_b32 s39, v12
s_cmp_ge_u32 s39, 4
s_cbranch_scc1 D_23
s_sleep 2
s_sub_u32 s36, s36, 1
s_cbranch_scc0 W_22
s_mov_b32 s36, 0
D_23:
ds_write_b128 v6, v[48:51] offset:0
ds_write_b128 v6, v[52:55] offset:1024
ds_write_b128 v6, v[56:59] offset:2048
ds_write_b128 v6, v[60:63] offset:3072
ds_write_b128 v6, v[64:67] offset:16384
ds_write_b128 v6, v[68:71] offset:17408
ds_write_b128 v6, v[72:75] offset:18432
ds_write_b128 v6, v[76:79] offset:19456
ds_write_b128 v6, v[80:83] offset:32768
ds_write_b128 v6, v[84:87] offset:33792
ds_write_b128 v6, v[88:91] offset:34816
ds_write_b128 v6, v[92:95] offset:35840
ds_write_b128 v6, v[96:99] offset:49152
ds_write_b128 v6, v[100:103] offset:50176
ds_write_b128 v6, v[104:107] offset:51200
ds_write_b128 v6, v[108:111] offset:52224
s_waitcnt lgkmcnt(0)
s_mov_b64 exec, 1
ds_add_u32 v4, v5 offset:20
s_mov_b64 exec, -1
W_24:
ds_read_b32 v13, v4 offset:20
s_waitcnt lgkmcnt(0)
v_readfirstlane_b32 s39, v13
s_cmp_ge_u32 s39, s59
s_cbranch_scc1 D_25
s_sub_u32 s36, s36, 1
s_cbranch_scc0 W_24
s_mov_b32 s36, 0
D_25:
ds_read_b128 v[48:51], v11 offset:0
ds_read_b128 v[52:55], v11 offset:1024
ds_read_b128 v[56:59], v11 offset:2048
ds_read_b128 v[60:63], v11 offset:3072
ds_read_b128 v[64:67], v11 offset:4096
ds_read_b128 v[68:71], v11 offset:5120
ds_read_b128 v[72:75], v11 offset:6144
ds_read_b128 v[76:79], v11 offset:7168
ds_read_b128 v[80:83], v11 offset:8192
ds_read_b128 v[84:87], v11 offset:9216
ds_read_b128 v[88:91], v11 offset:10240
ds_read_b128 v[92:95], v11 offset:11264
ds_read_b128 v[96:99], v11 offset:12288
ds_read_b128 v[100:103], v11 offset:13312
ds_read_b128 v[104:107], v11 offset:14336
ds_read_b128 v[108:111], v11 offset:15360
ds_read_b32 v112, v7 offset:3072
ds_read_b32 v113, v7 offset:7168
ds_read_b32 v114, v7 offset:11264
ds_read_b32 v115, v7 offset:15360
ds_read_b32 v116, v7 offset:19456
ds_read_b32 v117, v7 offset:23552
ds_read_b32 v118, v7 offset:27648
ds_read_b32 v119, v7 offset:31744
ds_read_b32 v120, v7 offset:35840
ds_read_b32 v121, v7 offset:39936
ds_read_b32 v122, v7 offset:44032
ds_read_b32 v123, v7 offset:48128
ds_read_b32 v124, v7 offset:52224
ds_read_b32 v125, v7 offset:56320
ds_read_b32 v126, v7 offset:60416
ds_read_b32 v127, v7 offset:64512
s_waitcnt lgkmcnt(0)
v_add_f32 v48, v48, v64
v_add_f32 v80, v80, v96
v_add_f32 v49, v49, v65
v_add_f32 v81, v81, v97
v_add_f32 v50, v50, v66
v_add_f32 v82, v82, v98
v_add_f32 v51, v51, v67
v_add_f32 v83, v83, v99
v_add_f32 v52, v52, v68
v_add_f32 v84, v84, v100
v_add_f32 v53, v53, v69
v_add_f32 v85, v85, v101
v_add_f32 v54, v54, v70
v_add_f32 v86, v86, v102
v_add_f32 v55, v55, v71
v_add_f32 v87, v87, v103
v_add_f32 v56, v56, v72
v_add_f32 v88, v88, v104
v_add_f32 v57, v57, v73
v_add_f32 v89, v89, v105
v_add_f32 v58, v58, v74
v_add_f32 v90, v90, v106
v_add_f32 v59, v59, v75
v_add_f32 v91, v91, v107
v_add_f32 v60, v60, v76
v_add_f32 v92, v92, v108
v_add_f32 v61, v61, v77
v_add_f32 v93, v93, v109
v_add_f32 v62, v62, v78
v_add_f32 v94, v94, v110
v_add_f32 v63, v63, v79
v_add_f32 v95, v95, v111
v_add_f32 v48, v48, v80
v_add_f32 v49, v49, v81
v_add_f32 v50, v50, v82
v_add_f32 v51, v51, v83
v_add_f32 v52, v52, v84
v_add_f32 v53, v53, v85
v_add_f32 v54, v54, v86
v_add_f32 v55, v55, v87
v_add_f32 v56, v56, v88
v_add_f32 v57, v57, v89
v_add_f32 v58, v58, v90
v_add_f32 v59, v59, v91
v_add_f32 v60, v60, v92
v_add_f32 v61, v61, v93
v_add_f32 v62, v62, v94
v_add_f32 v63, v63, v95
s_mov_b64 s[62:63], 0
v_add_f32 v112, v112, v113
v_add_f32 v114, v114, v115
v_add_f32 v112, v112, v114
v_cmp_nle_f32 vcc, 0x2b800000, v112
s_or_b64 s[62:63], s[62:63], vcc
v_cmp_nge_f32 vcc, 0x53800000, v112
s_or_b64 s[62:63], s[62:63], vcc
v_add_f32 v116, v116, v117
v_add_f32 v118, v118, v119
v_add_f32 v116, v116, v118
v_cmp_nle_f32 vcc, 0x2b800000, v116
s_or_b64 s[62:63], s[62:63], vcc
v_cmp_nge_f32 vcc, 0x53800000, v116
s_or_b64 s[62:63], s[62:63], vcc
v_add_f32 v120, v120, v121
v_add_f32 v122, v122, v123
v_add_f32 v120, v120, v122
v_cmp_nle_f32 vcc, 0x2b800000, v120
s_or_b64 s[62:63], s[62:63], vcc
v_cmp_nge_f32 vcc, 0x53800000, v120
s_or_b64 s[62:63], s[62:63], vcc
v_add_f32 v124, v124, v125
v_add_f32 v126, v126, v127
v_add_f32 v124, v124, v126
v_cmp_nle_f32 vcc, 0x2b800000, v124
s_or_b64 s[62:63], s[62:63], vcc
v_cmp_nge_f32 vcc, 0x53800000, v124
s_or_b64 s[62:63], s[62:63], vcc
s_and_b64 s[62:63], s[62:63], s[54:55]
s_add_u32 s59, s59, 4
s_cmp_eq_u32 s58, 0
s_cselect_b64 s[62:63], s[62:63], 0
s_cmp_lg_u64 s[62:63], 0
s_cbranch_scc1 FALLBACK
v_mov_b32 v12, v60
v_mov_b32 v13, v60
s_nop 1
v_permlane32_swap_b32 v12, v13
s_nop 1
v_rcp_f32 v13, v13
s_nop 0
v_mul_f32 v48, v48, v13
v_mul_f32 v49, v49, v13
v_mul_f32 v50, v50, v13
v_mul_f32 v51, v51, v13
v_mul_f32 v52, v52, v13
v_mul_f32 v53, v53, v13
v_mul_f32 v54, v54, v13
v_mul_f32 v55, v55, v13
v_mul_f32 v56, v56, v13
v_mul_f32 v57, v57, v13
v_mul_f32 v58, v58, v13
v_mul_f32 v59, v59, v13
v_mul_f32 v60, v60, v13
v_mul_f32 v61, v61, v13
v_mul_f32 v62, v62, v13
v_mul_f32 v63, v63, v13
v_cvt_pk_bf16_f32 v144, v48, v49
v_cvt_pk_bf16_f32 v145, v50, v51
v_cvt_pk_bf16_f32 v146, v52, v53
v_cvt_pk_bf16_f32 v147, v54, v55
v_cvt_pk_bf16_f32 v148, v56, v57
v_cvt_pk_bf16_f32 v149, v58, v59
v_cvt_pk_bf16_f32 v150, v60, v61
v_cvt_pk_bf16_f32 v151, v62, v63
v_mov_b32 v12, 0
v_cndmask_b32 v150, v150, v12, s[54:55]
v_cndmask_b32 v151, v151, v12, s[54:55]
s_lshl_b32 s40, s53, 2
s_add_u32 s40, s40, s3
s_lshl_b32 s40, s40, 15
s_lshl_b32 s41, s52, 11
s_add_u32 s40, s40, s41
s_add_u32 s40, s40, 8388608
v_add_u32 v6, s40, v7
global_store_dwordx4 v6, v[144:147], s[30:31] sc1
global_store_dwordx4 v6, v[148:151], s[30:31] offset:1024 sc1
s_waitcnt vmcnt(0)
s_mov_b64 exec, 1
ds_add_rtn_u32 v12, v4, v5 offset:24
s_mov_b64 exec, -1
s_waitcnt lgkmcnt(0)
v_readfirstlane_b32 s39, v12
s_cmp_eq_u32 s39, 7
s_cbranch_scc0 sk_26
s_lshl_b32 s40, s53, 7
s_lshl_b32 s41, s52, 3
s_add_u32 s40, s40, s41
s_add_u32 s40, s40, 16384
v_mov_b32 v6, s40
v_mov_b32 v8, s37
v_mov_b32 v9, s38
s_mov_b64 exec, 1
global_store_dwordx2 v6, v[8:9], s[30:31] sc1
s_mov_b64 exec, -1
sk_26:
s_barrier
s_endpgm
FALLBACK:
s_mov_b32 s58, 1
v_lshlrev_b32 v7, 4, v0
v_add_u32 v8, s61, v7
s_mov_b32 s60, 16
v_mov_b32 v144, 0xff7fffff
v_mov_b32 v145, 0xff7fffff
v_mov_b32 v146, 0xff7fffff
v_mov_b32 v147, 0xff7fffff
FBL:
global_load_dwordx4 v[160:163], v8, s[30:31] sc1
global_load_dwordx4 v[164:167], v8, s[30:31] offset:1024 sc1
v_add_u32 v8, 2048, v8
s_waitcnt vmcnt(0)
v_mfma_f32_32x32x16_bf16 v[112:127], v[160:163], v[16:19], 0
v_mfma_f32_32x32x16_bf16 v[112:127], v[164:167], v[20:23], v[112:127]
s_nop 7
s_nop 7
s_nop 3
v_max3_f32 v144, v112, v113, v144
v_max3_f32 v144, v114, v115, v144
v_max3_f32 v144, v116, v117, v144
v_max3_f32 v144, v118, v119, v144
v_max3_f32 v144, v120, v121, v144
v_max3_f32 v144, v122, v123, v144
v_max3_f32 v144, v124, v125, v144
v_max3_f32 v144, v126, v127, v144
v_mfma_f32_32x32x16_bf16 v[112:127], v[160:163], v[24:27], 0
v_mfma_f32_32x32x16_bf16 v[112:127], v[164:167], v[28:31], v[112:127]
s_nop 7
s_nop 7
s_nop 3
v_max3_f32 v145, v112, v113, v145
v_max3_f32 v145, v114, v115, v145
v_max3_f32 v145, v116, v117, v145
v_max3_f32 v145, v118, v119, v145
v_max3_f32 v145, v120, v121, v145
v_max3_f32 v145, v122, v123, v145
v_max3_f32 v145, v124, v125, v145
v_max3_f32 v145, v126, v127, v145
v_mfma_f32_32x32x16_bf16 v[112:127], v[160:163], v[32:35], 0
v_mfma_f32_32x32x16_bf16 v[112:127], v[164:167], v[36:39], v[112:127]
s_nop 7
s_nop 7
s_nop 3
v_max3_f32 v146, v112, v113, v146
v_max3_f32 v146, v114, v115, v146
v_max3_f32 v146, v116, v117, v146
v_max3_f32 v146, v118, v119, v146
v_max3_f32 v146, v120, v121, v146
v_max3_f32 v146, v122, v123, v146
v_max3_f32 v146, v124, v125, v146
v_max3_f32 v146, v126, v127, v146
v_mfma_f32_32x32x16_bf16 v[112:127], v[160:163], v[40:43], 0
v_mfma_f32_32x32x16_bf16 v[112:127], v[164:167], v[44:47], v[112:127]
s_nop 7
s_nop 7
s_nop 3
v_max3_f32 v147, v112, v113, v147
v_max3_f32 v147, v114, v115, v147
v_max3_f32 v147, v116, v117, v147
v_max3_f32 v147, v118, v119, v147
v_max3_f32 v147, v120, v121, v147
v_max3_f32 v147, v122, v123, v147
v_max3_f32 v147, v124, v125, v147
v_max3_f32 v147, v126, v127, v147
s_sub_u32 s60, s60, 1
s_cmp_lg_u32 s60, 0
s_cbranch_scc1 FBL
s_lshl_b32 s40, s3, 10
v_lshlrev_b32 v6, 2, v0
v_add_u32 v11, s40, v6
s_mov_b64 exec, 1
ds_add_u32 v4, v5 offset:64
s_mov_b64 exec, -1
W_27:
ds_read_b32 v13, v4 offset:64
s_waitcnt lgkmcnt(0)
v_readfirstlane_b32 s39, v13
s_cmp_ge_u32 s39, 4
s_cbranch_scc1 D_28
s_sub_u32 s36, s36, 1
s_cbranch_scc0 W_27
s_mov_b32 s36, 0
D_28:
ds_write_b32 v11, v144 offset:0
ds_write_b32 v11, v145 offset:256
ds_write_b32 v11, v146 offset:512
ds_write_b32 v11, v147 offset:768
s_waitcnt lgkmcnt(0)
s_mov_b64 exec, 1
ds_add_u32 v4, v5 offset:64
s_mov_b64 exec, -1
W_29:
ds_read_b32 v13, v4 offset:64
s_waitcnt lgkmcnt(0)
v_readfirstlane_b32 s39, v13
s_cmp_ge_u32 s39, 8
s_cbranch_scc1 D_30
s_sub_u32 s36, s36, 1
s_cbranch_scc0 W_29
s_mov_b32 s36, 0
D_30:
v_xor_b32 v12, 128, v6
ds_read_b32 v112, v6 offset:0
ds_read_b32 v113, v12 offset:0
ds_read_b32 v114, v6 offset:1024
ds_read_b32 v115, v12 offset:1024
ds_read_b32 v116, v6 offset:2048
ds_read_b32 v117, v12 offset:2048
ds_read_b32 v118, v6 offset:3072
ds_read_b32 v119, v12 offset:3072
ds_read_b32 v120, v6 offset:256
ds_read_b32 v121, v12 offset:256
ds_read_b32 v122, v6 offset:1280
ds_read_b32 v123, v12 offset:1280
ds_read_b32 v124, v6 offset:2304
ds_read_b32 v125, v12 offset:2304
ds_read_b32 v126, v6 offset:3328
ds_read_b32 v127, v12 offset:3328
ds_read_b32 v128, v6 offset:512
ds_read_b32 v129, v12 offset:512
ds_read_b32 v130, v6 offset:1536
ds_read_b32 v131, v12 offset:1536
ds_read_b32 v132, v6 offset:2560
ds_read_b32 v133, v12 offset:2560
ds_read_b32 v134, v6 offset:3584
ds_read_b32 v135, v12 offset:3584
ds_read_b32 v136, v6 offset:768
ds_read_b32 v137, v12 offset:768
ds_read_b32 v138, v6 offset:1792
ds_read_b32 v139, v12 offset:1792
ds_read_b32 v140, v6 offset:2816
ds_read_b32 v141, v12 offset:2816
ds_read_b32 v142, v6 offset:3840
ds_read_b32 v143, v12 offset:3840
s_waitcnt lgkmcnt(0)
s_mov_b64 exec, 1
ds_add_u32 v4, v5 offset:64
s_mov_b64 exec, -1
W_31:
ds_read_b32 v13, v4 offset:64
s_waitcnt lgkmcnt(0)
v_readfirstlane_b32 s39, v13
s_cmp_ge_u32 s39, 12
s_cbranch_scc1 D_32
s_sub_u32 s36, s36, 1
s_cbranch_scc0 W_31
s_mov_b32 s36, 0
D_32:
v_max3_f32 v112, v112, v113, v114
v_max3_f32 v112, v112, v115, v116
v_max3_f32 v112, v112, v117, v118
v_max_f32 v112, v112, v119
v_sub_f32 v112, 0, v112
v_cvt_pk_bf16_f32 v113, v112, v112
v_and_b32 v113, 0xffff0000, v113
v_sub_f32 v114, v112, v113
v_cvt_pk_bf16_f32 v115, v114, v114
v_and_b32 v115, 0xffff0000, v115
v_sub_f32 v116, v114, v115
v_cvt_pk_bf16_f32 v117, v113, v115
v_cvt_pk_bf16_f32 v118, v116, 0
v_cndmask_b32 v22, v22, v117, s[54:55]
v_cndmask_b32 v23, v23, v118, s[54:55]
v_max3_f32 v120, v120, v121, v122
v_max3_f32 v120, v120, v123, v124
v_max3_f32 v120, v120, v125, v126
v_max_f32 v120, v120, v127
v_sub_f32 v120, 0, v120
v_cvt_pk_bf16_f32 v121, v120, v120
v_and_b32 v121, 0xffff0000, v121
v_sub_f32 v122, v120, v121
v_cvt_pk_bf16_f32 v123, v122, v122
v_and_b32 v123, 0xffff0000, v123
v_sub_f32 v124, v122, v123
v_cvt_pk_bf16_f32 v125, v121, v123
v_cvt_pk_bf16_f32 v126, v124, 0
v_cndmask_b32 v30, v30, v125, s[54:55]
v_cndmask_b32 v31, v31, v126, s[54:55]
v_max3_f32 v128, v128, v129, v130
v_max3_f32 v128, v128, v131, v132
v_max3_f32 v128, v128, v133, v134
v_max_f32 v128, v128, v135
v_sub_f32 v128, 0, v128
v_cvt_pk_bf16_f32 v129, v128, v128
v_and_b32 v129, 0xffff0000, v129
v_sub_f32 v130, v128, v129
v_cvt_pk_bf16_f32 v131, v130, v130
v_and_b32 v131, 0xffff0000, v131
v_sub_f32 v132, v130, v131
v_cvt_pk_bf16_f32 v133, v129, v131
v_cvt_pk_bf16_f32 v134, v132, 0
v_cndmask_b32 v38, v38, v133, s[54:55]
v_cndmask_b32 v39, v39, v134, s[54:55]
v_max3_f32 v136, v136, v137, v138
v_max3_f32 v136, v136, v139, v140
v_max3_f32 v136, v136, v141, v142
v_max_f32 v136, v136, v143
v_sub_f32 v136, 0, v136
v_cvt_pk_bf16_f32 v137, v136, v136
v_and_b32 v137, 0xffff0000, v137
v_sub_f32 v138, v136, v137
v_cvt_pk_bf16_f32 v139, v138, v138
v_and_b32 v139, 0xffff0000, v139
v_sub_f32 v140, v138, v139
v_cvt_pk_bf16_f32 v141, v137, v139
v_cvt_pk_bf16_f32 v142, v140, 0
v_cndmask_b32 v46, v46, v141, s[54:55]
v_cndmask_b32 v47, v47, v142, s[54:55]
v_mov_b32 v48, 0
v_mov_b32 v49, 0
v_mov_b32 v50, 0
v_mov_b32 v51, 0
v_mov_b32 v52, 0
v_mov_b32 v53, 0
v_mov_b32 v54, 0
v_mov_b32 v55, 0
v_mov_b32 v56, 0
v_mov_b32 v57, 0
v_mov_b32 v58, 0
v_mov_b32 v59, 0
v_mov_b32 v60, 0
v_mov_b32 v61, 0
v_mov_b32 v62, 0
v_mov_b32 v63, 0
v_mov_b32 v64, 0
v_mov_b32 v65, 0
v_mov_b32 v66, 0
v_mov_b32 v67, 0
v_mov_b32 v68, 0
v_mov_b32 v69, 0
v_mov_b32 v70, 0
v_mov_b32 v71, 0
v_mov_b32 v72, 0
v_mov_b32 v73, 0
v_mov_b32 v74, 0
v_mov_b32 v75, 0
v_mov_b32 v76, 0
v_mov_b32 v77, 0
v_mov_b32 v78, 0
v_mov_b32 v79, 0
v_mov_b32 v80, 0
v_mov_b32 v81, 0
v_mov_b32 v82, 0
v_mov_b32 v83, 0
v_mov_b32 v84, 0
v_mov_b32 v85, 0
v_mov_b32 v86, 0
v_mov_b32 v87, 0
v_mov_b32 v88, 0
v_mov_b32 v89, 0
v_mov_b32 v90, 0
v_mov_b32 v91, 0
v_mov_b32 v92, 0
v_mov_b32 v93, 0
v_mov_b32 v94, 0
v_mov_b32 v95, 0
v_mov_b32 v96, 0
v_mov_b32 v97, 0
v_mov_b32 v98, 0
v_mov_b32 v99, 0
v_mov_b32 v100, 0
v_mov_b32 v101, 0
v_mov_b32 v102, 0
v_mov_b32 v103, 0
v_mov_b32 v104, 0
v_mov_b32 v105, 0
v_mov_b32 v106, 0
v_mov_b32 v107, 0
v_mov_b32 v108, 0
v_mov_b32 v109, 0
v_mov_b32 v110, 0
v_mov_b32 v111, 0
s_branch RERUN
SPATH:
s_sub_u32 s52, s3, 4
s_lshr_b32 s53, s52, 1
s_and_b32 s58, s52, 1
s_mul_i32 s59, s34, 56
s_lshl_b32 s40, s35, 1
s_add_u32 s59, s59, s40
s_add_u32 s60, s59, s53
s_lshr_b32 s62, s35, 3
s_and_b32 s40, s35, 7
s_and_b32 s41, s34, 1
s_lshl_b32 s41, s41, 5
s_lshr_b32 s61, s34, 1
s_lshl_b32 s61, s61, 3
s_add_u32 s61, s61, s41
s_add_u32 s61, s40, s61
v_cmp_eq_u32 s[54:55], 1, v2
s_mov_b32 s63, 140032
s_cmp_ge_u32 s35, 28
s_cbranch_scc1 SNOSSM
s_lshl_b32 s40, s60, 9
s_lshl_b32 s41, s58, 8
s_add_u32 s40, s40, s41
v_lshl_add_u32 v6, v0, 2, s40
s_lshl_b32 s41, s60, 1
v_mov_b32 v7, s41
global_load_ushort v232, v7, s[14:15]
global_load_ushort v233, v7, s[16:17]
global_load_dword v8, v6, s[6:7]
global_load_dword v9, v6, s[8:9]
global_load_dword v10, v6, s[10:11]
global_load_dword v11, v6, s[12:13]
s_barrier
s_mul_i32 s41, s62, 224
v_add_u32 v6, 0, v0
v_mul_u32_u24 v7, 0x4925, v6
v_lshrrev_b32 v7, 18, v7
v_mul_u32_u24 v12, 14, v7
v_sub_u32 v6, v6, v12
v_lshlrev_b32 v6, 4, v6
v_mul_u32_u24 v7, 896, v7
v_add3_u32 v240, v6, v7, s41
v_add_u32 v6, 64, v0
v_mul_u32_u24 v7, 0x4925, v6
v_lshrrev_b32 v7, 18, v7
v_mul_u32_u24 v12, 14, v7
v_sub_u32 v6, v6, v12
v_lshlrev_b32 v6, 4, v6
v_mul_u32_u24 v7, 896, v7
v_add3_u32 v241, v6, v7, s41
v_add_u32 v6, 128, v0
v_mul_u32_u24 v7, 0x4925, v6
v_lshrrev_b32 v7, 18, v7
v_mul_u32_u24 v12, 14, v7
v_sub_u32 v6, v6, v12
v_lshlrev_b32 v6, 4, v6
v_mul_u32_u24 v7, 896, v7
v_add3_u32 v242, v6, v7, s41
v_add_u32 v6, 192, v0
v_mul_u32_u24 v7, 0x4925, v6
v_lshrrev_b32 v7, 18, v7
v_mul_u32_u24 v12, 14, v7
v_sub_u32 v6, v6, v12
v_lshlrev_b32 v6, 4, v6
v_mul_u32_u24 v7, 896, v7
v_add3_u32 v243, v6, v7, s41
v_add_u32 v6, 256, v0
v_mul_u32_u24 v7, 0x4925, v6
v_lshrrev_b32 v7, 18, v7
v_mul_u32_u24 v12, 14, v7
v_sub_u32 v6, v6, v12
v_lshlrev_b32 v6, 4, v6
v_mul_u32_u24 v7, 896, v7
v_add3_u32 v244, v6, v7, s41
v_add_u32 v6, 320, v0
v_mul_u32_u24 v7, 0x4925, v6
v_lshrrev_b32 v7, 18, v7
v_mul_u32_u24 v12, 14, v7
v_sub_u32 v6, v6, v12
v_lshlrev_b32 v6, 4, v6
v_mul_u32_u24 v7, 896, v7
v_add3_u32 v245, v6, v7, s41
v_add_u32 v6, 384, v0
v_mul_u32_u24 v7, 0x4925, v6
v_lshrrev_b32 v7, 18, v7
v_mul_u32_u24 v12, 14, v7
v_sub_u32 v6, v6, v12
v_lshlrev_b32 v6, 4, v6
v_mul_u32_u24 v7, 896, v7
v_add3_u32 v246, v6, v7, s41
s_waitcnt vmcnt(0)
s_mov_b64 exec, 1
ds_add_u32 v4, v5 offset:24
s_mov_b64 exec, -1
v_mov_b32 v234, v8
v_mov_b32 v235, v9
v_mov_b32 v236, v10
v_mov_b32 v237, v11
v_lshl_add_u32 v6, s52, 6, v0
v_sub_u32 v6, 255, v6
v_subrev_u32 v7, 0, v6
v_max_i32 v8, 0, v7
v_or_b32 v8, 16, v8
v_ffbh_u32 v8, v8
v_sub_u32 v8, 27, v8
v_lshlrev_b32 v9, v8, v5
v_add_u32 v9, -1, v9
v_add_u32 v10, 1, v8
v_lshlrev_b32 v11, 8, v8
v_add_u32 v11, 155776, v11
v_lshlrev_b32 v12, 3, v7
v_add_u32 v13, 7, v12
v_bfe_u32 v14, v13, v8, 1
v_lshl_add_u32 v13, v13, 1, v9
v_add_u32 v13, v13, v14
v_lshrrev_b32 v13, v10, v13
v_lshl_add_u32 v208, v13, 1, v11
v_add_u32 v13, 6, v12
v_bfe_u32 v14, v13, v8, 1
v_lshl_add_u32 v13, v13, 1, v9
v_add_u32 v13, v13, v14
v_lshrrev_b32 v13, v10, v13
v_lshl_add_u32 v209, v13, 1, v11
v_add_u32 v13, 5, v12
v_bfe_u32 v14, v13, v8, 1
v_lshl_add_u32 v13, v13, 1, v9
v_add_u32 v13, v13, v14
v_lshrrev_b32 v13, v10, v13
v_lshl_add_u32 v210, v13, 1, v11
v_add_u32 v13, 4, v12
v_bfe_u32 v14, v13, v8, 1
v_lshl_add_u32 v13, v13, 1, v9
v_add_u32 v13, v13, v14
v_lshrrev_b32 v13, v10, v13
v_lshl_add_u32 v211, v13, 1, v11
v_add_u32 v13, 3, v12
v_bfe_u32 v14, v13, v8, 1
v_lshl_add_u32 v13, v13, 1, v9
v_add_u32 v13, v13, v14
v_lshrrev_b32 v13, v10, v13
v_lshl_add_u32 v212, v13, 1, v11
v_add_u32 v13, 2, v12
v_bfe_u32 v14, v13, v8, 1
v_lshl_add_u32 v13, v13, 1, v9
v_add_u32 v13, v13, v14
v_lshrrev_b32 v13, v10, v13
v_lshl_add_u32 v213, v13, 1, v11
v_add_u32 v13, 1, v12
v_bfe_u32 v14, v13, v8, 1
v_lshl_add_u32 v13, v13, 1, v9
v_add_u32 v13, v13, v14
v_lshrrev_b32 v13, v10, v13
v_lshl_add_u32 v214, v13, 1, v11
v_add_u32 v13, 0, v12
v_bfe_u32 v14, v13, v8, 1
v_lshl_add_u32 v13, v13, 1, v9
v_add_u32 v13, v13, v14
v_lshrrev_b32 v13, v10, v13
v_lshl_add_u32 v215, v13, 1, v11
v_subrev_u32 v7, 1, v6
v_max_i32 v8, 0, v7
v_or_b32 v8, 16, v8
v_ffbh_u32 v8, v8
v_sub_u32 v8, 27, v8
v_lshlrev_b32 v9, v8, v5
v_add_u32 v9, -1, v9
v_add_u32 v10, 1, v8
v_lshlrev_b32 v11, 8, v8
v_add_u32 v11, 155776, v11
v_lshlrev_b32 v12, 3, v7
v_add_u32 v13, 7, v12
v_bfe_u32 v14, v13, v8, 1
v_lshl_add_u32 v13, v13, 1, v9
v_add_u32 v13, v13, v14
v_lshrrev_b32 v13, v10, v13
v_lshl_add_u32 v216, v13, 1, v11
v_cmp_gt_i32 vcc, 0, v7
v_mov_b32 v14, 157064
s_nop 0
v_cndmask_b32 v216, v216, v14, vcc
v_add_u32 v13, 6, v12
v_bfe_u32 v14, v13, v8, 1
v_lshl_add_u32 v13, v13, 1, v9
v_add_u32 v13, v13, v14
v_lshrrev_b32 v13, v10, v13
v_lshl_add_u32 v217, v13, 1, v11
v_cmp_gt_i32 vcc, 0, v7
v_mov_b32 v14, 157064
s_nop 0
v_cndmask_b32 v217, v217, v14, vcc
v_add_u32 v13, 5, v12
v_bfe_u32 v14, v13, v8, 1
v_lshl_add_u32 v13, v13, 1, v9
v_add_u32 v13, v13, v14
v_lshrrev_b32 v13, v10, v13
v_lshl_add_u32 v218, v13, 1, v11
v_cmp_gt_i32 vcc, 0, v7
v_mov_b32 v14, 157064
s_nop 0
v_cndmask_b32 v218, v218, v14, vcc
v_add_u32 v13, 4, v12
v_bfe_u32 v14, v13, v8, 1
v_lshl_add_u32 v13, v13, 1, v9
v_add_u32 v13, v13, v14
v_lshrrev_b32 v13, v10, v13
v_lshl_add_u32 v219, v13, 1, v11
v_cmp_gt_i32 vcc, 0, v7
v_mov_b32 v14, 157064
s_nop 0
v_cndmask_b32 v219, v219, v14, vcc
v_add_u32 v13, 3, v12
v_bfe_u32 v14, v13, v8, 1
v_lshl_add_u32 v13, v13, 1, v9
v_add_u32 v13, v13, v14
v_lshrrev_b32 v13, v10, v13
v_lshl_add_u32 v220, v13, 1, v11
v_cmp_gt_i32 vcc, 0, v7
v_mov_b32 v14, 157064
s_nop 0
v_cndmask_b32 v220, v220, v14, vcc
v_add_u32 v13, 2, v12
v_bfe_u32 v14, v13, v8, 1
v_lshl_add_u32 v13, v13, 1, v9
v_add_u32 v13, v13, v14
v_lshrrev_b32 v13, v10, v13
v_lshl_add_u32 v221, v13, 1, v11
v_cmp_gt_i32 vcc, 0, v7
v_mov_b32 v14, 157064
s_nop 0
v_cndmask_b32 v221, v221, v14, vcc
v_add_u32 v13, 1, v12
v_bfe_u32 v14, v13, v8, 1
v_lshl_add_u32 v13, v13, 1, v9
v_add_u32 v13, v13, v14
v_lshrrev_b32 v13, v10, v13
v_lshl_add_u32 v222, v13, 1, v11
v_cmp_gt_i32 vcc, 0, v7
v_mov_b32 v14, 157064
s_nop 0
v_cndmask_b32 v222, v222, v14, vcc
v_add_u32 v13, 0, v12
v_bfe_u32 v14, v13, v8, 1
v_lshl_add_u32 v13, v13, 1, v9
v_add_u32 v13, v13, v14
v_lshrrev_b32 v13, v10, v13
v_lshl_add_u32 v223, v13, 1, v11
v_cmp_gt_i32 vcc, 0, v7
v_mov_b32 v14, 157064
s_nop 0
v_cndmask_b32 v223, v223, v14, vcc
v_mov_b32 v8, v234
v_mov_b32 v9, v235
v_mov_b32 v10, v236
v_mov_b32 v11, v237
s_mul_i32 s40, s52, 9216
s_add_u32 s40, s40, 118784
v_mul_u32_u24 v6, 144, v0
v_add_u32 v6, s40, v6
v_lshrrev_b32 v28, 2, v0
v_and_b32 v28, 3, v28
v_lshl_add_u32 v28, v2, 2, v28
v_mul_u32_u24 v28, 144, v28
v_bfe_u32 v29, v0, 4, 1
v_lshlrev_b32 v29, 5, v29
v_and_b32 v30, 3, v0
v_lshlrev_b32 v30, 3, v30
v_add3_u32 v28, v28, v29, v30
v_add_u32 v7, s40, v28
s_waitcnt vmcnt(0)
v_lshlrev_b32 v12, 16, v232
v_mul_f32 v12, 0x3fb8aa3b, v12
v_exp_f32 v12, v12
s_nop 0
v_cvt_pk_bf16_f32 v12, v12, v12
v_lshlrev_b32 v12, 16, v12
v_add_f32 v13, v12, v12
v_lshlrev_b32 v233, 16, v233
v_lshlrev_b32 v28, 16, v8
v_lshlrev_b32 v29, 16, v9
v_lshlrev_b32 v24, 16, v10
v_lshlrev_b32 v25, 16, v11
v_mul_f32 v28, 0x3fb8aa3b, v28
v_exp_f32 v28, v28
v_mul_f32 v27, v29, v12
v_cvt_pk_bf16_f32 v28, v28, v28
v_lshlrev_b32 v28, 16, v28
v_mul_f32 v26, v28, v12
v_mul_f32 v26, 0xbfb8aa3b, v26
v_mul_f32 v27, 0x3e22f983, v27
v_mul_f32 v24, v24, v13
v_mul_f32 v25, v25, v13
v_mul_f32 v32, 1.0, v26
v_mul_f32 v33, 1.0, v27
v_mul_f32 v34, 0x41000000, v26
v_mul_f32 v35, 0x41000000, v27
v_mul_f32 v36, 0x43800000, v26
v_mul_f32 v37, 0x43800000, v27
v_exp_f32 v32, v32
v_fract_f32 v33, v33
v_exp_f32 v34, v34
v_fract_f32 v35, v35
v_exp_f32 v36, v36
v_fract_f32 v37, v37
v_cos_f32 v14, v33
v_sin_f32 v15, v33
v_cos_f32 v16, v35
v_sin_f32 v17, v35
v_cos_f32 v18, v37
v_sin_f32 v19, v37
s_nop 0
v_mul_f32 v14, v14, v32
v_mul_f32 v15, v15, v32
v_mul_f32 v16, v16, v34
v_mul_f32 v17, v17, v34
v_mul_f32 v18, v18, v36
v_mul_f32 v19, v19, v36
v_mov_b32 v32, 1.0
v_mov_b32 v33, 0
v_mov_b32 v34, v16
v_mov_b32 v35, v17
v_pk_mul_f32 v[36:37], v[16:17], v[16:17] op_sel:[0,0] op_sel_hi:[0,1]
v_pk_mul_f32 v[20:21], v[14:15], v[14:15] op_sel:[0,0] op_sel_hi:[0,1]
v_pk_fma_f32 v[36:37], v[16:17], v[16:17], v[36:37] op_sel:[1,1,0] op_sel_hi:[1,0,1] neg_lo:[1,0,0]
v_pk_fma_f32 v[20:21], v[14:15], v[14:15], v[20:21] op_sel:[1,1,0] op_sel_hi:[1,0,1] neg_lo:[1,0,0]
v_pk_mul_f32 v[38:39], v[36:37], v[16:17] op_sel:[0,0] op_sel_hi:[0,1]
v_pk_mul_f32 v[40:41], v[36:37], v[36:37] op_sel:[0,0] op_sel_hi:[0,1]
v_pk_mul_f32 v[22:23], v[20:21], v[20:21] op_sel:[0,0] op_sel_hi:[0,1]
v_pk_fma_f32 v[38:39], v[36:37], v[16:17], v[38:39] op_sel:[1,1,0] op_sel_hi:[1,0,1] neg_lo:[1,0,0]
v_pk_fma_f32 v[40:41], v[36:37], v[36:37], v[40:41] op_sel:[1,1,0] op_sel_hi:[1,0,1] neg_lo:[1,0,0]
v_pk_fma_f32 v[22:23], v[20:21], v[20:21], v[22:23] op_sel:[1,1,0] op_sel_hi:[1,0,1] neg_lo:[1,0,0]
v_pk_mul_f32 v[42:43], v[34:35], v[40:41] op_sel:[0,0] op_sel_hi:[0,1]
v_pk_mul_f32 v[44:45], v[36:37], v[40:41] op_sel:[0,0] op_sel_hi:[0,1]
v_pk_mul_f32 v[46:47], v[38:39], v[40:41] op_sel:[0,0] op_sel_hi:[0,1]
v_pk_fma_f32 v[42:43], v[34:35], v[40:41], v[42:43] op_sel:[1,1,0] op_sel_hi:[1,0,1] neg_lo:[1,0,0]
v_pk_fma_f32 v[44:45], v[36:37], v[40:41], v[44:45] op_sel:[1,1,0] op_sel_hi:[1,0,1] neg_lo:[1,0,0]
v_pk_fma_f32 v[46:47], v[38:39], v[40:41], v[46:47] op_sel:[1,1,0] op_sel_hi:[1,0,1] neg_lo:[1,0,0]
v_pk_mul_f32 v[48:49], v[40:41], v[40:41] op_sel:[0,0] op_sel_hi:[0,1]
v_pk_mul_f32 v[50:51], v[42:43], v[40:41] op_sel:[0,0] op_sel_hi:[0,1]
v_pk_mul_f32 v[52:53], v[44:45], v[40:41] op_sel:[0,0] op_sel_hi:[0,1]
v_pk_mul_f32 v[54:55], v[46:47], v[40:41] op_sel:[0,0] op_sel_hi:[0,1]
v_pk_fma_f32 v[48:49], v[40:41], v[40:41], v[48:49] op_sel:[1,1,0] op_sel_hi:[1,0,1] neg_lo:[1,0,0]
v_pk_fma_f32 v[50:51], v[42:43], v[40:41], v[50:51] op_sel:[1,1,0] op_sel_hi:[1,0,1] neg_lo:[1,0,0]
v_pk_fma_f32 v[52:53], v[44:45], v[40:41], v[52:53] op_sel:[1,1,0] op_sel_hi:[1,0,1] neg_lo:[1,0,0]
v_pk_fma_f32 v[54:55], v[46:47], v[40:41], v[54:55] op_sel:[1,1,0] op_sel_hi:[1,0,1] neg_lo:[1,0,0]
v_pk_mul_f32 v[56:57], v[48:49], v[40:41] op_sel:[0,0] op_sel_hi:[0,1]
v_pk_mul_f32 v[58:59], v[50:51], v[40:41] op_sel:[0,0] op_sel_hi:[0,1]
v_pk_mul_f32 v[60:61], v[52:53], v[40:41] op_sel:[0,0] op_sel_hi:[0,1]
v_pk_mul_f32 v[62:63], v[54:55], v[40:41] op_sel:[0,0] op_sel_hi:[0,1]
v_pk_fma_f32 v[56:57], v[48:49], v[40:41], v[56:57] op_sel:[1,1,0] op_sel_hi:[1,0,1] neg_lo:[1,0,0]
v_pk_fma_f32 v[58:59], v[50:51], v[40:41], v[58:59] op_sel:[1,1,0] op_sel_hi:[1,0,1] neg_lo:[1,0,0]
v_pk_fma_f32 v[60:61], v[52:53], v[40:41], v[60:61] op_sel:[1,1,0] op_sel_hi:[1,0,1] neg_lo:[1,0,0]
v_pk_fma_f32 v[62:63], v[54:55], v[40:41], v[62:63] op_sel:[1,1,0] op_sel_hi:[1,0,1] neg_lo:[1,0,0]
v_pk_mul_f32 v[64:65], v[56:57], v[40:41] op_sel:[0,0] op_sel_hi:[0,1]
v_pk_mul_f32 v[66:67], v[58:59], v[40:41] op_sel:[0,0] op_sel_hi:[0,1]
v_pk_mul_f32 v[68:69], v[60:61], v[40:41] op_sel:[0,0] op_sel_hi:[0,1]
v_pk_mul_f32 v[70:71], v[62:63], v[40:41] op_sel:[0,0] op_sel_hi:[0,1]
v_pk_fma_f32 v[64:65], v[56:57], v[40:41], v[64:65] op_sel:[1,1,0] op_sel_hi:[1,0,1] neg_lo:[1,0,0]
v_pk_fma_f32 v[66:67], v[58:59], v[40:41], v[66:67] op_sel:[1,1,0] op_sel_hi:[1,0,1] neg_lo:[1,0,0]
v_pk_fma_f32 v[68:69], v[60:61], v[40:41], v[68:69] op_sel:[1,1,0] op_sel_hi:[1,0,1] neg_lo:[1,0,0]
v_pk_fma_f32 v[70:71], v[62:63], v[40:41], v[70:71] op_sel:[1,1,0] op_sel_hi:[1,0,1] neg_lo:[1,0,0]
v_pk_mul_f32 v[72:73], v[64:65], v[40:41] op_sel:[0,0] op_sel_hi:[0,1]
v_pk_mul_f32 v[74:75], v[66:67], v[40:41] op_sel:[0,0] op_sel_hi:[0,1]
v_pk_mul_f32 v[76:77], v[68:69], v[40:41] op_sel:[0,0] op_sel_hi:[0,1]
v_pk_mul_f32 v[78:79], v[70:71], v[40:41] op_sel:[0,0] op_sel_hi:[0,1]
v_pk_fma_f32 v[72:73], v[64:65], v[40:41], v[72:73] op_sel:[1,1,0] op_sel_hi:[1,0,1] neg_lo:[1,0,0]
v_pk_fma_f32 v[74:75], v[66:67], v[40:41], v[74:75] op_sel:[1,1,0] op_sel_hi:[1,0,1] neg_lo:[1,0,0]
v_pk_fma_f32 v[76:77], v[68:69], v[40:41], v[76:77] op_sel:[1,1,0] op_sel_hi:[1,0,1] neg_lo:[1,0,0]
v_pk_fma_f32 v[78:79], v[70:71], v[40:41], v[78:79] op_sel:[1,1,0] op_sel_hi:[1,0,1] neg_lo:[1,0,0]
v_pk_mul_f32 v[80:81], v[72:73], v[40:41] op_sel:[0,0] op_sel_hi:[0,1]
v_pk_mul_f32 v[82:83], v[74:75], v[40:41] op_sel:[0,0] op_sel_hi:[0,1]
v_pk_mul_f32 v[84:85], v[76:77], v[40:41] op_sel:[0,0] op_sel_hi:[0,1]
v_pk_mul_f32 v[86:87], v[78:79], v[40:41] op_sel:[0,0] op_sel_hi:[0,1]
v_pk_fma_f32 v[80:81], v[72:73], v[40:41], v[80:81] op_sel:[1,1,0] op_sel_hi:[1,0,1] neg_lo:[1,0,0]
v_pk_fma_f32 v[82:83], v[74:75], v[40:41], v[82:83] op_sel:[1,1,0] op_sel_hi:[1,0,1] neg_lo:[1,0,0]
v_pk_fma_f32 v[84:85], v[76:77], v[40:41], v[84:85] op_sel:[1,1,0] op_sel_hi:[1,0,1] neg_lo:[1,0,0]
v_pk_fma_f32 v[86:87], v[78:79], v[40:41], v[86:87] op_sel:[1,1,0] op_sel_hi:[1,0,1] neg_lo:[1,0,0]
v_pk_mul_f32 v[88:89], v[80:81], v[40:41] op_sel:[0,0] op_sel_hi:[0,1]
v_pk_mul_f32 v[90:91], v[82:83], v[40:41] op_sel:[0,0] op_sel_hi:[0,1]
v_pk_mul_f32 v[92:93], v[84:85], v[40:41] op_sel:[0,0] op_sel_hi:[0,1]
v_pk_mul_f32 v[94:95], v[86:87], v[40:41] op_sel:[0,0] op_sel_hi:[0,1]
v_pk_fma_f32 v[88:89], v[80:81], v[40:41], v[88:89] op_sel:[1,1,0] op_sel_hi:[1,0,1] neg_lo:[1,0,0]
v_pk_fma_f32 v[90:91], v[82:83], v[40:41], v[90:91] op_sel:[1,1,0] op_sel_hi:[1,0,1] neg_lo:[1,0,0]
v_pk_fma_f32 v[92:93], v[84:85], v[40:41], v[92:93] op_sel:[1,1,0] op_sel_hi:[1,0,1] neg_lo:[1,0,0]
v_pk_fma_f32 v[94:95], v[86:87], v[40:41], v[94:95] op_sel:[1,1,0] op_sel_hi:[1,0,1] neg_lo:[1,0,0]
v_cvt_pk_bf16_f32 v96, v32, v34
v_cvt_pk_bf16_f32 v112, v33, v35
v_cvt_pk_bf16_f32 v97, v36, v38
v_cvt_pk_bf16_f32 v113, v37, v39
v_cvt_pk_bf16_f32 v98, v40, v42
v_cvt_pk_bf16_f32 v114, v41, v43
v_cvt_pk_bf16_f32 v99, v44, v46
v_cvt_pk_bf16_f32 v115, v45, v47
v_cvt_pk_bf16_f32 v100, v48, v50
v_cvt_pk_bf16_f32 v116, v49, v51
v_cvt_pk_bf16_f32 v101, v52, v54
v_cvt_pk_bf16_f32 v117, v53, v55
v_cvt_pk_bf16_f32 v102, v56, v58
v_cvt_pk_bf16_f32 v118, v57, v59
v_cvt_pk_bf16_f32 v103, v60, v62
v_cvt_pk_bf16_f32 v119, v61, v63
v_cvt_pk_bf16_f32 v104, v64, v66
v_cvt_pk_bf16_f32 v120, v65, v67
v_cvt_pk_bf16_f32 v105, v68, v70
v_cvt_pk_bf16_f32 v121, v69, v71
v_cvt_pk_bf16_f32 v106, v72, v74
v_cvt_pk_bf16_f32 v122, v73, v75
v_cvt_pk_bf16_f32 v107, v76, v78
v_cvt_pk_bf16_f32 v123, v77, v79
v_cvt_pk_bf16_f32 v108, v80, v82
v_cvt_pk_bf16_f32 v124, v81, v83
v_cvt_pk_bf16_f32 v109, v84, v86
v_cvt_pk_bf16_f32 v125, v85, v87
v_cvt_pk_bf16_f32 v110, v88, v90
v_cvt_pk_bf16_f32 v126, v89, v91
v_cvt_pk_bf16_f32 v111, v92, v94
v_cvt_pk_bf16_f32 v127, v93, v95
ds_write_b128 v6, v[96:99] offset:0
ds_write_b128 v6, v[100:103] offset:16
ds_write_b128 v6, v[104:107] offset:32
ds_write_b128 v6, v[108:111] offset:48
ds_write_b128 v6, v[112:115] offset:64
ds_write_b128 v6, v[116:119] offset:80
ds_write_b128 v6, v[120:123] offset:96
ds_write_b128 v6, v[124:127] offset:112
ds_read_b64_tr_b16 v[128:129], v7 offset:0
ds_read_b64_tr_b16 v[130:131], v7 offset:64
ds_read_b64_tr_b16 v[132:133], v7 offset:1152
ds_read_b64_tr_b16 v[134:135], v7 offset:1216
ds_read_b64_tr_b16 v[136:137], v7 offset:2304
ds_read_b64_tr_b16 v[138:139], v7 offset:2368
ds_read_b64_tr_b16 v[140:141], v7 offset:3456
ds_read_b64_tr_b16 v[142:143], v7 offset:3520
ds_read_b64_tr_b16 v[144:145], v7 offset:4608
ds_read_b64_tr_b16 v[146:147], v7 offset:4672
ds_read_b64_tr_b16 v[148:149], v7 offset:5760
ds_read_b64_tr_b16 v[150:151], v7 offset:5824
ds_read_b64_tr_b16 v[152:153], v7 offset:6912
ds_read_b64_tr_b16 v[154:155], v7 offset:6976
ds_read_b64_tr_b16 v[156:157], v7 offset:8064
ds_read_b64_tr_b16 v[158:159], v7 offset:8128
v_mov_b32 v32, v24
v_mov_b32 v33, v25
v_pk_mul_f32 v[34:35], v[32:33], v[14:15] op_sel:[0,0] op_sel_hi:[0,1]
v_pk_mul_f32 v[48:49], v[32:33], v[18:19] op_sel:[0,0] op_sel_hi:[0,1]
v_pk_mul_f32 v[36:37], v[32:33], v[20:21] op_sel:[0,0] op_sel_hi:[0,1]
v_pk_fma_f32 v[34:35], v[32:33], v[14:15], v[34:35] op_sel:[1,1,0] op_sel_hi:[1,0,1] neg_lo:[1,0,0]
v_pk_fma_f32 v[48:49], v[32:33], v[18:19], v[48:49] op_sel:[1,1,0] op_sel_hi:[1,0,1] neg_lo:[1,0,0]
v_pk_fma_f32 v[36:37], v[32:33], v[20:21], v[36:37] op_sel:[1,1,0] op_sel_hi:[1,0,1] neg_lo:[1,0,0]
v_pk_mul_f32 v[38:39], v[34:35], v[20:21] op_sel:[0,0] op_sel_hi:[0,1]
v_pk_mul_f32 v[56:57], v[48:49], v[18:19] op_sel:[0,0] op_sel_hi:[0,1]
v_pk_mul_f32 v[40:41], v[36:37], v[20:21] op_sel:[0,0] op_sel_hi:[0,1]
v_pk_mul_f32 v[50:51], v[48:49], v[20:21] op_sel:[0,0] op_sel_hi:[0,1]
v_pk_fma_f32 v[38:39], v[34:35], v[20:21], v[38:39] op_sel:[1,1,0] op_sel_hi:[1,0,1] neg_lo:[1,0,0]
v_pk_fma_f32 v[56:57], v[48:49], v[18:19], v[56:57] op_sel:[1,1,0] op_sel_hi:[1,0,1] neg_lo:[1,0,0]
v_pk_fma_f32 v[40:41], v[36:37], v[20:21], v[40:41] op_sel:[1,1,0] op_sel_hi:[1,0,1] neg_lo:[1,0,0]
v_pk_fma_f32 v[50:51], v[48:49], v[20:21], v[50:51] op_sel:[1,1,0] op_sel_hi:[1,0,1] neg_lo:[1,0,0]
v_pk_mul_f32 v[42:43], v[38:39], v[20:21] op_sel:[0,0] op_sel_hi:[0,1]
v_pk_mul_f32 v[60:61], v[56:57], v[18:19] op_sel:[0,0] op_sel_hi:[0,1]
v_pk_mul_f32 v[44:45], v[40:41], v[20:21] op_sel:[0,0] op_sel_hi:[0,1]
v_pk_mul_f32 v[52:53], v[50:51], v[20:21] op_sel:[0,0] op_sel_hi:[0,1]
v_pk_mul_f32 v[58:59], v[56:57], v[22:23] op_sel:[0,0] op_sel_hi:[0,1]
v_pk_fma_f32 v[42:43], v[38:39], v[20:21], v[42:43] op_sel:[1,1,0] op_sel_hi:[1,0,1] neg_lo:[1,0,0]
v_pk_fma_f32 v[60:61], v[56:57], v[18:19], v[60:61] op_sel:[1,1,0] op_sel_hi:[1,0,1] neg_lo:[1,0,0]
v_pk_fma_f32 v[44:45], v[40:41], v[20:21], v[44:45] op_sel:[1,1,0] op_sel_hi:[1,0,1] neg_lo:[1,0,0]
v_pk_fma_f32 v[52:53], v[50:51], v[20:21], v[52:53] op_sel:[1,1,0] op_sel_hi:[1,0,1] neg_lo:[1,0,0]
v_pk_fma_f32 v[58:59], v[56:57], v[22:23], v[58:59] op_sel:[1,1,0] op_sel_hi:[1,0,1] neg_lo:[1,0,0]
v_pk_mul_f32 v[46:47], v[42:43], v[20:21] op_sel:[0,0] op_sel_hi:[0,1]
v_pk_mul_f32 v[64:65], v[60:61], v[18:19] op_sel:[0,0] op_sel_hi:[0,1]
v_pk_mul_f32 v[54:55], v[52:53], v[20:21] op_sel:[0,0] op_sel_hi:[0,1]
v_pk_mul_f32 v[62:63], v[60:61], v[22:23] op_sel:[0,0] op_sel_hi:[0,1]
v_pk_fma_f32 v[46:47], v[42:43], v[20:21], v[46:47] op_sel:[1,1,0] op_sel_hi:[1,0,1] neg_lo:[1,0,0]
v_pk_fma_f32 v[64:65], v[60:61], v[18:19], v[64:65] op_sel:[1,1,0] op_sel_hi:[1,0,1] neg_lo:[1,0,0]
v_pk_fma_f32 v[54:55], v[52:53], v[20:21], v[54:55] op_sel:[1,1,0] op_sel_hi:[1,0,1] neg_lo:[1,0,0]
v_pk_fma_f32 v[62:63], v[60:61], v[22:23], v[62:63] op_sel:[1,1,0] op_sel_hi:[1,0,1] neg_lo:[1,0,0]
v_pk_mul_f32 v[66:67], v[64:65], v[18:19] op_sel:[0,0] op_sel_hi:[0,1]
v_pk_fma_f32 v[66:67], v[64:65], v[18:19], v[66:67] op_sel:[1,1,0] op_sel_hi:[1,0,1] neg_lo:[1,0,0]
v_pk_mul_f32 v[68:69], v[66:67], v[18:19] op_sel:[0,0] op_sel_hi:[0,1]
v_pk_fma_f32 v[68:69], v[66:67], v[18:19], v[68:69] op_sel:[1,1,0] op_sel_hi:[1,0,1] neg_lo:[1,0,0]
v_pk_mul_f32 v[70:71], v[68:69], v[18:19] op_sel:[0,0] op_sel_hi:[0,1]
v_pk_fma_f32 v[70:71], v[68:69], v[18:19], v[70:71] op_sel:[1,1,0] op_sel_hi:[1,0,1] neg_lo:[1,0,0]
v_pk_mul_f32 v[72:73], v[70:71], v[18:19] op_sel:[0,0] op_sel_hi:[0,1]
v_pk_fma_f32 v[72:73], v[70:71], v[18:19], v[72:73] op_sel:[1,1,0] op_sel_hi:[1,0,1] neg_lo:[1,0,0]
v_cvt_pk_bf16_f32 v96, v32, v34
v_cvt_pk_bf16_f32 v112, -v33, -v35
v_cvt_pk_bf16_f32 v97, v36, v38
v_cvt_pk_bf16_f32 v113, -v37, -v39
v_cvt_pk_bf16_f32 v98, v40, v42
v_cvt_pk_bf16_f32 v114, -v41, -v43
v_cvt_pk_bf16_f32 v99, v44, v46
v_cvt_pk_bf16_f32 v115, -v45, -v47
v_cvt_pk_bf16_f32 v100, v48, v50
v_cvt_pk_bf16_f32 v116, -v49, -v51
v_cvt_pk_bf16_f32 v101, v52, v54
v_cvt_pk_bf16_f32 v117, -v53, -v55
v_cvt_pk_bf16_f32 v102, v56, v58
v_cvt_pk_bf16_f32 v118, -v57, -v59
v_cvt_pk_bf16_f32 v103, v60, v62
v_cvt_pk_bf16_f32 v119, -v61, -v63
v_cvt_pk_bf16_f32 v104, v64, v66
v_cvt_pk_bf16_f32 v120, -v65, -v67
v_cvt_pk_bf16_f32 v105, v68, v70
v_cvt_pk_bf16_f32 v121, -v69, -v71
v_cvt_pk_bf16_f32 v106, v72, v74
v_cvt_pk_bf16_f32 v122, -v73, -v75
v_cvt_pk_bf16_f32 v107, v76, v78
v_cvt_pk_bf16_f32 v123, -v77, -v79
s_waitcnt lgkmcnt(0)
ds_write_b128 v6, v[96:99] offset:0
ds_write_b128 v6, v[112:115] offset:64
ds_write_b128 v6, v[100:103] offset:16
ds_write_b128 v6, v[116:119] offset:80
ds_write_b128 v6, v[104:107] offset:32
ds_write_b128 v6, v[120:123] offset:96
ds_read_b64_tr_b16 v[160:161], v7 offset:0
ds_read_b64_tr_b16 v[162:163], v7 offset:64
ds_read_b64_tr_b16 v[164:165], v7 offset:1152
ds_read_b64_tr_b16 v[166:167], v7 offset:1216
ds_read_b64_tr_b16 v[168:169], v7 offset:2304
ds_read_b64_tr_b16 v[170:171], v7 offset:2368
ds_read_b64_tr_b16 v[172:173], v7 offset:3456
ds_read_b64_tr_b16 v[174:175], v7 offset:3520
ds_read_b64_tr_b16 v[176:177], v7 offset:4608
ds_read_b64_tr_b16 v[178:179], v7 offset:4672
ds_read_b64_tr_b16 v[180:181], v7 offset:5760
ds_read_b64_tr_b16 v[182:183], v7 offset:5824
ds_read_b64_tr_b16 v[184:185], v7 offset:6912
ds_read_b64_tr_b16 v[186:187], v7 offset:6976
ds_read_b64_tr_b16 v[188:189], v7 offset:8064
ds_read_b64_tr_b16 v[190:191], v7 offset:8128
s_waitcnt lgkmcnt(0)
v_mfma_f32_32x32x16_bf16 v[192:207], v[160:163], v[128:131], 0
v_mfma_f32_32x32x16_bf16 v[192:207], v[164:167], v[132:135], v[192:207]
v_mfma_f32_32x32x16_bf16 v[192:207], v[168:171], v[136:139], v[192:207]
v_mfma_f32_32x32x16_bf16 v[192:207], v[172:175], v[140:143], v[192:207]
v_mfma_f32_32x32x16_bf16 v[192:207], v[176:179], v[144:147], v[192:207]
v_mfma_f32_32x32x16_bf16 v[192:207], v[180:183], v[148:151], v[192:207]
v_mfma_f32_32x32x16_bf16 v[192:207], v[184:187], v[152:155], v[192:207]
v_mfma_f32_32x32x16_bf16 v[192:207], v[188:191], v[156:159], v[192:207]
v_and_b32 v28, 0xffff0000, v8
v_and_b32 v29, 0xffff0000, v9
v_and_b32 v24, 0xffff0000, v10
v_and_b32 v25, 0xffff0000, v11
v_mul_f32 v28, 0x3fb8aa3b, v28
v_exp_f32 v28, v28
v_mul_f32 v27, v29, v12
v_cvt_pk_bf16_f32 v28, v28, v28
v_lshlrev_b32 v28, 16, v28
v_mul_f32 v26, v28, v12
v_mul_f32 v26, 0xbfb8aa3b, v26
v_mul_f32 v27, 0x3e22f983, v27
v_mul_f32 v24, v24, v13
v_mul_f32 v25, v25, v13
v_mul_f32 v32, 1.0, v26
v_mul_f32 v33, 1.0, v27
v_mul_f32 v34, 0x41000000, v26
v_mul_f32 v35, 0x41000000, v27
v_mul_f32 v36, 0x43800000, v26
v_mul_f32 v37, 0x43800000, v27
v_exp_f32 v32, v32
v_fract_f32 v33, v33
v_exp_f32 v34, v34
v_fract_f32 v35, v35
v_exp_f32 v36, v36
v_fract_f32 v37, v37
v_cos_f32 v14, v33
v_sin_f32 v15, v33
v_cos_f32 v16, v35
v_sin_f32 v17, v35
v_cos_f32 v18, v37
v_sin_f32 v19, v37
s_nop 0
v_mul_f32 v14, v14, v32
v_mul_f32 v15, v15, v32
v_mul_f32 v16, v16, v34
v_mul_f32 v17, v17, v34
v_mul_f32 v18, v18, v36
v_mul_f32 v19, v19, v36
v_mov_b32 v32, 1.0
v_mov_b32 v33, 0
v_mov_b32 v34, v16
v_mov_b32 v35, v17
v_pk_mul_f32 v[36:37], v[16:17], v[16:17] op_sel:[0,0] op_sel_hi:[0,1]
v_pk_mul_f32 v[20:21], v[14:15], v[14:15] op_sel:[0,0] op_sel_hi:[0,1]
v_pk_fma_f32 v[36:37], v[16:17], v[16:17], v[36:37] op_sel:[1,1,0] op_sel_hi:[1,0,1] neg_lo:[1,0,0]
v_pk_fma_f32 v[20:21], v[14:15], v[14:15], v[20:21] op_sel:[1,1,0] op_sel_hi:[1,0,1] neg_lo:[1,0,0]
v_pk_mul_f32 v[38:39], v[36:37], v[16:17] op_sel:[0,0] op_sel_hi:[0,1]
v_pk_mul_f32 v[40:41], v[36:37], v[36:37] op_sel:[0,0] op_sel_hi:[0,1]
v_pk_mul_f32 v[22:23], v[20:21], v[20:21] op_sel:[0,0] op_sel_hi:[0,1]
v_pk_fma_f32 v[38:39], v[36:37], v[16:17], v[38:39] op_sel:[1,1,0] op_sel_hi:[1,0,1] neg_lo:[1,0,0]
v_pk_fma_f32 v[40:41], v[36:37], v[36:37], v[40:41] op_sel:[1,1,0] op_sel_hi:[1,0,1] neg_lo:[1,0,0]
v_pk_fma_f32 v[22:23], v[20:21], v[20:21], v[22:23] op_sel:[1,1,0] op_sel_hi:[1,0,1] neg_lo:[1,0,0]
v_pk_mul_f32 v[42:43], v[34:35], v[40:41] op_sel:[0,0] op_sel_hi:[0,1]
v_pk_mul_f32 v[44:45], v[36:37], v[40:41] op_sel:[0,0] op_sel_hi:[0,1]
v_pk_mul_f32 v[46:47], v[38:39], v[40:41] op_sel:[0,0] op_sel_hi:[0,1]
v_pk_fma_f32 v[42:43], v[34:35], v[40:41], v[42:43] op_sel:[1,1,0] op_sel_hi:[1,0,1] neg_lo:[1,0,0]
v_pk_fma_f32 v[44:45], v[36:37], v[40:41], v[44:45] op_sel:[1,1,0] op_sel_hi:[1,0,1] neg_lo:[1,0,0]
v_pk_fma_f32 v[46:47], v[38:39], v[40:41], v[46:47] op_sel:[1,1,0] op_sel_hi:[1,0,1] neg_lo:[1,0,0]
v_pk_mul_f32 v[48:49], v[40:41], v[40:41] op_sel:[0,0] op_sel_hi:[0,1]
v_pk_mul_f32 v[50:51], v[42:43], v[40:41] op_sel:[0,0] op_sel_hi:[0,1]
v_pk_mul_f32 v[52:53], v[44:45], v[40:41] op_sel:[0,0] op_sel_hi:[0,1]
v_pk_mul_f32 v[54:55], v[46:47], v[40:41] op_sel:[0,0] op_sel_hi:[0,1]
v_pk_fma_f32 v[48:49], v[40:41], v[40:41], v[48:49] op_sel:[1,1,0] op_sel_hi:[1,0,1] neg_lo:[1,0,0]
v_pk_fma_f32 v[50:51], v[42:43], v[40:41], v[50:51] op_sel:[1,1,0] op_sel_hi:[1,0,1] neg_lo:[1,0,0]
v_pk_fma_f32 v[52:53], v[44:45], v[40:41], v[52:53] op_sel:[1,1,0] op_sel_hi:[1,0,1] neg_lo:[1,0,0]
v_pk_fma_f32 v[54:55], v[46:47], v[40:41], v[54:55] op_sel:[1,1,0] op_sel_hi:[1,0,1] neg_lo:[1,0,0]
v_pk_mul_f32 v[56:57], v[48:49], v[40:41] op_sel:[0,0] op_sel_hi:[0,1]
v_pk_mul_f32 v[58:59], v[50:51], v[40:41] op_sel:[0,0] op_sel_hi:[0,1]
v_pk_mul_f32 v[60:61], v[52:53], v[40:41] op_sel:[0,0] op_sel_hi:[0,1]
v_pk_mul_f32 v[62:63], v[54:55], v[40:41] op_sel:[0,0] op_sel_hi:[0,1]
v_pk_fma_f32 v[56:57], v[48:49], v[40:41], v[56:57] op_sel:[1,1,0] op_sel_hi:[1,0,1] neg_lo:[1,0,0]
v_pk_fma_f32 v[58:59], v[50:51], v[40:41], v[58:59] op_sel:[1,1,0] op_sel_hi:[1,0,1] neg_lo:[1,0,0]
v_pk_fma_f32 v[60:61], v[52:53], v[40:41], v[60:61] op_sel:[1,1,0] op_sel_hi:[1,0,1] neg_lo:[1,0,0]
v_pk_fma_f32 v[62:63], v[54:55], v[40:41], v[62:63] op_sel:[1,1,0] op_sel_hi:[1,0,1] neg_lo:[1,0,0]
v_pk_mul_f32 v[64:65], v[56:57], v[40:41] op_sel:[0,0] op_sel_hi:[0,1]
v_pk_mul_f32 v[66:67], v[58:59], v[40:41] op_sel:[0,0] op_sel_hi:[0,1]
v_pk_mul_f32 v[68:69], v[60:61], v[40:41] op_sel:[0,0] op_sel_hi:[0,1]
v_pk_mul_f32 v[70:71], v[62:63], v[40:41] op_sel:[0,0] op_sel_hi:[0,1]
v_pk_fma_f32 v[64:65], v[56:57], v[40:41], v[64:65] op_sel:[1,1,0] op_sel_hi:[1,0,1] neg_lo:[1,0,0]
v_pk_fma_f32 v[66:67], v[58:59], v[40:41], v[66:67] op_sel:[1,1,0] op_sel_hi:[1,0,1] neg_lo:[1,0,0]
v_pk_fma_f32 v[68:69], v[60:61], v[40:41], v[68:69] op_sel:[1,1,0] op_sel_hi:[1,0,1] neg_lo:[1,0,0]
v_pk_fma_f32 v[70:71], v[62:63], v[40:41], v[70:71] op_sel:[1,1,0] op_sel_hi:[1,0,1] neg_lo:[1,0,0]
v_pk_mul_f32 v[72:73], v[64:65], v[40:41] op_sel:[0,0] op_sel_hi:[0,1]
v_pk_mul_f32 v[74:75], v[66:67], v[40:41] op_sel:[0,0] op_sel_hi:[0,1]
v_pk_mul_f32 v[76:77], v[68:69], v[40:41] op_sel:[0,0] op_sel_hi:[0,1]
v_pk_mul_f32 v[78:79], v[70:71], v[40:41] op_sel:[0,0] op_sel_hi:[0,1]
v_pk_fma_f32 v[72:73], v[64:65], v[40:41], v[72:73] op_sel:[1,1,0] op_sel_hi:[1,0,1] neg_lo:[1,0,0]
v_pk_fma_f32 v[74:75], v[66:67], v[40:41], v[74:75] op_sel:[1,1,0] op_sel_hi:[1,0,1] neg_lo:[1,0,0]
v_pk_fma_f32 v[76:77], v[68:69], v[40:41], v[76:77] op_sel:[1,1,0] op_sel_hi:[1,0,1] neg_lo:[1,0,0]
v_pk_fma_f32 v[78:79], v[70:71], v[40:41], v[78:79] op_sel:[1,1,0] op_sel_hi:[1,0,1] neg_lo:[1,0,0]
v_pk_mul_f32 v[80:81], v[72:73], v[40:41] op_sel:[0,0] op_sel_hi:[0,1]
v_pk_mul_f32 v[82:83], v[74:75], v[40:41] op_sel:[0,0] op_sel_hi:[0,1]
v_pk_mul_f32 v[84:85], v[76:77], v[40:41] op_sel:[0,0] op_sel_hi:[0,1]
v_pk_mul_f32 v[86:87], v[78:79], v[40:41] op_sel:[0,0] op_sel_hi:[0,1]
v_pk_fma_f32 v[80:81], v[72:73], v[40:41], v[80:81] op_sel:[1,1,0] op_sel_hi:[1,0,1] neg_lo:[1,0,0]
v_pk_fma_f32 v[82:83], v[74:75], v[40:41], v[82:83] op_sel:[1,1,0] op_sel_hi:[1,0,1] neg_lo:[1,0,0]
v_pk_fma_f32 v[84:85], v[76:77], v[40:41], v[84:85] op_sel:[1,1,0] op_sel_hi:[1,0,1] neg_lo:[1,0,0]
v_pk_fma_f32 v[86:87], v[78:79], v[40:41], v[86:87] op_sel:[1,1,0] op_sel_hi:[1,0,1] neg_lo:[1,0,0]
v_pk_mul_f32 v[88:89], v[80:81], v[40:41] op_sel:[0,0] op_sel_hi:[0,1]
v_pk_mul_f32 v[90:91], v[82:83], v[40:41] op_sel:[0,0] op_sel_hi:[0,1]
v_pk_mul_f32 v[92:93], v[84:85], v[40:41] op_sel:[0,0] op_sel_hi:[0,1]
v_pk_mul_f32 v[94:95], v[86:87], v[40:41] op_sel:[0,0] op_sel_hi:[0,1]
v_pk_fma_f32 v[88:89], v[80:81], v[40:41], v[88:89] op_sel:[1,1,0] op_sel_hi:[1,0,1] neg_lo:[1,0,0]
v_pk_fma_f32 v[90:91], v[82:83], v[40:41], v[90:91] op_sel:[1,1,0] op_sel_hi:[1,0,1] neg_lo:[1,0,0]
v_pk_fma_f32 v[92:93], v[84:85], v[40:41], v[92:93] op_sel:[1,1,0] op_sel_hi:[1,0,1] neg_lo:[1,0,0]
v_pk_fma_f32 v[94:95], v[86:87], v[40:41], v[94:95] op_sel:[1,1,0] op_sel_hi:[1,0,1] neg_lo:[1,0,0]
v_cvt_pk_bf16_f32 v96, v32, v34
v_cvt_pk_bf16_f32 v112, v33, v35
v_cvt_pk_bf16_f32 v97, v36, v38
v_cvt_pk_bf16_f32 v113, v37, v39
v_cvt_pk_bf16_f32 v98, v40, v42
v_cvt_pk_bf16_f32 v114, v41, v43
v_cvt_pk_bf16_f32 v99, v44, v46
v_cvt_pk_bf16_f32 v115, v45, v47
v_cvt_pk_bf16_f32 v100, v48, v50
v_cvt_pk_bf16_f32 v116, v49, v51
v_cvt_pk_bf16_f32 v101, v52, v54
v_cvt_pk_bf16_f32 v117, v53, v55
v_cvt_pk_bf16_f32 v102, v56, v58
v_cvt_pk_bf16_f32 v118, v57, v59
v_cvt_pk_bf16_f32 v103, v60, v62
v_cvt_pk_bf16_f32 v119, v61, v63
v_cvt_pk_bf16_f32 v104, v64, v66
v_cvt_pk_bf16_f32 v120, v65, v67
v_cvt_pk_bf16_f32 v105, v68, v70
v_cvt_pk_bf16_f32 v121, v69, v71
v_cvt_pk_bf16_f32 v106, v72, v74
v_cvt_pk_bf16_f32 v122, v73, v75
v_cvt_pk_bf16_f32 v107, v76, v78
v_cvt_pk_bf16_f32 v123, v77, v79
v_cvt_pk_bf16_f32 v108, v80, v82
v_cvt_pk_bf16_f32 v124, v81, v83
v_cvt_pk_bf16_f32 v109, v84, v86
v_cvt_pk_bf16_f32 v125, v85, v87
v_cvt_pk_bf16_f32 v110, v88, v90
v_cvt_pk_bf16_f32 v126, v89, v91
v_cvt_pk_bf16_f32 v111, v92, v94
v_cvt_pk_bf16_f32 v127, v93, v95
ds_write_b128 v6, v[96:99] offset:0
ds_write_b128 v6, v[100:103] offset:16
ds_write_b128 v6, v[104:107] offset:32
ds_write_b128 v6, v[108:111] offset:48
ds_write_b128 v6, v[112:115] offset:64
ds_write_b128 v6, v[116:119] offset:80
ds_write_b128 v6, v[120:123] offset:96
ds_write_b128 v6, v[124:127] offset:112
ds_read_b64_tr_b16 v[128:129], v7 offset:0
ds_read_b64_tr_b16 v[130:131], v7 offset:64
ds_read_b64_tr_b16 v[132:133], v7 offset:1152
ds_read_b64_tr_b16 v[134:135], v7 offset:1216
ds_read_b64_tr_b16 v[136:137], v7 offset:2304
ds_read_b64_tr_b16 v[138:139], v7 offset:2368
ds_read_b64_tr_b16 v[140:141], v7 offset:3456
ds_read_b64_tr_b16 v[142:143], v7 offset:3520
ds_read_b64_tr_b16 v[144:145], v7 offset:4608
ds_read_b64_tr_b16 v[146:147], v7 offset:4672
ds_read_b64_tr_b16 v[148:149], v7 offset:5760
ds_read_b64_tr_b16 v[150:151], v7 offset:5824
ds_read_b64_tr_b16 v[152:153], v7 offset:6912
ds_read_b64_tr_b16 v[154:155], v7 offset:6976
ds_read_b64_tr_b16 v[156:157], v7 offset:8064
ds_read_b64_tr_b16 v[158:159], v7 offset:8128
v_mov_b32 v32, v24
v_mov_b32 v33, v25
v_pk_mul_f32 v[34:35], v[32:33], v[14:15] op_sel:[0,0] op_sel_hi:[0,1]
v_pk_mul_f32 v[48:49], v[32:33], v[18:19] op_sel:[0,0] op_sel_hi:[0,1]
v_pk_mul_f32 v[36:37], v[32:33], v[20:21] op_sel:[0,0] op_sel_hi:[0,1]
v_pk_fma_f32 v[34:35], v[32:33], v[14:15], v[34:35] op_sel:[1,1,0] op_sel_hi:[1,0,1] neg_lo:[1,0,0]
v_pk_fma_f32 v[48:49], v[32:33], v[18:19], v[48:49] op_sel:[1,1,0] op_sel_hi:[1,0,1] neg_lo:[1,0,0]
v_pk_fma_f32 v[36:37], v[32:33], v[20:21], v[36:37] op_sel:[1,1,0] op_sel_hi:[1,0,1] neg_lo:[1,0,0]
v_pk_mul_f32 v[38:39], v[34:35], v[20:21] op_sel:[0,0] op_sel_hi:[0,1]
v_pk_mul_f32 v[56:57], v[48:49], v[18:19] op_sel:[0,0] op_sel_hi:[0,1]
v_pk_mul_f32 v[40:41], v[36:37], v[20:21] op_sel:[0,0] op_sel_hi:[0,1]
v_pk_mul_f32 v[50:51], v[48:49], v[20:21] op_sel:[0,0] op_sel_hi:[0,1]
v_pk_fma_f32 v[38:39], v[34:35], v[20:21], v[38:39] op_sel:[1,1,0] op_sel_hi:[1,0,1] neg_lo:[1,0,0]
v_pk_fma_f32 v[56:57], v[48:49], v[18:19], v[56:57] op_sel:[1,1,0] op_sel_hi:[1,0,1] neg_lo:[1,0,0]
v_pk_fma_f32 v[40:41], v[36:37], v[20:21], v[40:41] op_sel:[1,1,0] op_sel_hi:[1,0,1] neg_lo:[1,0,0]
v_pk_fma_f32 v[50:51], v[48:49], v[20:21], v[50:51] op_sel:[1,1,0] op_sel_hi:[1,0,1] neg_lo:[1,0,0]
v_pk_mul_f32 v[42:43], v[38:39], v[20:21] op_sel:[0,0] op_sel_hi:[0,1]
v_pk_mul_f32 v[60:61], v[56:57], v[18:19] op_sel:[0,0] op_sel_hi:[0,1]
v_pk_mul_f32 v[44:45], v[40:41], v[20:21] op_sel:[0,0] op_sel_hi:[0,1]
v_pk_mul_f32 v[52:53], v[50:51], v[20:21] op_sel:[0,0] op_sel_hi:[0,1]
v_pk_mul_f32 v[58:59], v[56:57], v[22:23] op_sel:[0,0] op_sel_hi:[0,1]
v_pk_fma_f32 v[42:43], v[38:39], v[20:21], v[42:43] op_sel:[1,1,0] op_sel_hi:[1,0,1] neg_lo:[1,0,0]
v_pk_fma_f32 v[60:61], v[56:57], v[18:19], v[60:61] op_sel:[1,1,0] op_sel_hi:[1,0,1] neg_lo:[1,0,0]
v_pk_fma_f32 v[44:45], v[40:41], v[20:21], v[44:45] op_sel:[1,1,0] op_sel_hi:[1,0,1] neg_lo:[1,0,0]
v_pk_fma_f32 v[52:53], v[50:51], v[20:21], v[52:53] op_sel:[1,1,0] op_sel_hi:[1,0,1] neg_lo:[1,0,0]
v_pk_fma_f32 v[58:59], v[56:57], v[22:23], v[58:59] op_sel:[1,1,0] op_sel_hi:[1,0,1] neg_lo:[1,0,0]
v_pk_mul_f32 v[46:47], v[42:43], v[20:21] op_sel:[0,0] op_sel_hi:[0,1]
v_pk_mul_f32 v[64:65], v[60:61], v[18:19] op_sel:[0,0] op_sel_hi:[0,1]
v_pk_mul_f32 v[54:55], v[52:53], v[20:21] op_sel:[0,0] op_sel_hi:[0,1]
v_pk_mul_f32 v[62:63], v[60:61], v[22:23] op_sel:[0,0] op_sel_hi:[0,1]
v_pk_fma_f32 v[46:47], v[42:43], v[20:21], v[46:47] op_sel:[1,1,0] op_sel_hi:[1,0,1] neg_lo:[1,0,0]
v_pk_fma_f32 v[64:65], v[60:61], v[18:19], v[64:65] op_sel:[1,1,0] op_sel_hi:[1,0,1] neg_lo:[1,0,0]
v_pk_fma_f32 v[54:55], v[52:53], v[20:21], v[54:55] op_sel:[1,1,0] op_sel_hi:[1,0,1] neg_lo:[1,0,0]
v_pk_fma_f32 v[62:63], v[60:61], v[22:23], v[62:63] op_sel:[1,1,0] op_sel_hi:[1,0,1] neg_lo:[1,0,0]
v_pk_mul_f32 v[66:67], v[64:65], v[18:19] op_sel:[0,0] op_sel_hi:[0,1]
v_pk_fma_f32 v[66:67], v[64:65], v[18:19], v[66:67] op_sel:[1,1,0] op_sel_hi:[1,0,1] neg_lo:[1,0,0]
v_pk_mul_f32 v[68:69], v[66:67], v[18:19] op_sel:[0,0] op_sel_hi:[0,1]
v_pk_fma_f32 v[68:69], v[66:67], v[18:19], v[68:69] op_sel:[1,1,0] op_sel_hi:[1,0,1] neg_lo:[1,0,0]
v_pk_mul_f32 v[70:71], v[68:69], v[18:19] op_sel:[0,0] op_sel_hi:[0,1]
v_pk_fma_f32 v[70:71], v[68:69], v[18:19], v[70:71] op_sel:[1,1,0] op_sel_hi:[1,0,1] neg_lo:[1,0,0]
v_pk_mul_f32 v[72:73], v[70:71], v[18:19] op_sel:[0,0] op_sel_hi:[0,1]
v_pk_fma_f32 v[72:73], v[70:71], v[18:19], v[72:73] op_sel:[1,1,0] op_sel_hi:[1,0,1] neg_lo:[1,0,0]
v_cvt_pk_bf16_f32 v96, v32, v34
v_cvt_pk_bf16_f32 v112, -v33, -v35
v_cvt_pk_bf16_f32 v97, v36, v38
v_cvt_pk_bf16_f32 v113, -v37, -v39
v_cvt_pk_bf16_f32 v98, v40, v42
v_cvt_pk_bf16_f32 v114, -v41, -v43
v_cvt_pk_bf16_f32 v99, v44, v46
v_cvt_pk_bf16_f32 v115, -v45, -v47
v_cvt_pk_bf16_f32 v100, v48, v50
v_cvt_pk_bf16_f32 v116, -v49, -v51
v_cvt_pk_bf16_f32 v101, v52, v54
v_cvt_pk_bf16_f32 v117, -v53, -v55
v_cvt_pk_bf16_f32 v102, v56, v58
v_cvt_pk_bf16_f32 v118, -v57, -v59
v_cvt_pk_bf16_f32 v103, v60, v62
v_cvt_pk_bf16_f32 v119, -v61, -v63
v_cvt_pk_bf16_f32 v104, v64, v66
v_cvt_pk_bf16_f32 v120, -v65, -v67
v_cvt_pk_bf16_f32 v105, v68, v70
v_cvt_pk_bf16_f32 v121, -v69, -v71
v_cvt_pk_bf16_f32 v106, v72, v74
v_cvt_pk_bf16_f32 v122, -v73, -v75
v_cvt_pk_bf16_f32 v107, v76, v78
v_cvt_pk_bf16_f32 v123, -v77, -v79
s_waitcnt lgkmcnt(0)
ds_write_b128 v6, v[96:99] offset:0
ds_write_b128 v6, v[112:115] offset:64
ds_write_b128 v6, v[100:103] offset:16
ds_write_b128 v6, v[116:119] offset:80
ds_write_b128 v6, v[104:107] offset:32
ds_write_b128 v6, v[120:123] offset:96
ds_read_b64_tr_b16 v[160:161], v7 offset:0
ds_read_b64_tr_b16 v[162:163], v7 offset:64
ds_read_b64_tr_b16 v[164:165], v7 offset:1152
ds_read_b64_tr_b16 v[166:167], v7 offset:1216
ds_read_b64_tr_b16 v[168:169], v7 offset:2304
ds_read_b64_tr_b16 v[170:171], v7 offset:2368
ds_read_b64_tr_b16 v[172:173], v7 offset:3456
ds_read_b64_tr_b16 v[174:175], v7 offset:3520
ds_read_b64_tr_b16 v[176:177], v7 offset:4608
ds_read_b64_tr_b16 v[178:179], v7 offset:4672
ds_read_b64_tr_b16 v[180:181], v7 offset:5760
ds_read_b64_tr_b16 v[182:183], v7 offset:5824
ds_read_b64_tr_b16 v[184:185], v7 offset:6912
ds_read_b64_tr_b16 v[186:187], v7 offset:6976
ds_read_b64_tr_b16 v[188:189], v7 offset:8064
ds_read_b64_tr_b16 v[190:191], v7 offset:8128
s_waitcnt lgkmcnt(0)
v_mfma_f32_32x32x16_bf16 v[192:207], v[160:163], v[128:131], v[192:207]
v_mfma_f32_32x32x16_bf16 v[192:207], v[164:167], v[132:135], v[192:207]
v_mfma_f32_32x32x16_bf16 v[192:207], v[168:171], v[136:139], v[192:207]
v_mfma_f32_32x32x16_bf16 v[192:207], v[172:175], v[140:143], v[192:207]
v_mfma_f32_32x32x16_bf16 v[192:207], v[176:179], v[144:147], v[192:207]
v_mfma_f32_32x32x16_bf16 v[192:207], v[180:183], v[148:151], v[192:207]
v_mfma_f32_32x32x16_bf16 v[192:207], v[184:187], v[152:155], v[192:207]
v_mfma_f32_32x32x16_bf16 v[192:207], v[188:191], v[156:159], v[192:207]
s_nop 7
s_nop 7
v_lshlrev_b32 v28, 4, v0
s_cmp_eq_u32 s58, 0
s_cbranch_scc1 k1_33
v_add_u32 v28, s40, v28
ds_write_b128 v28, v[192:195] offset:0
ds_write_b128 v28, v[196:199] offset:1024
ds_write_b128 v28, v[200:203] offset:2048
s_waitcnt lgkmcnt(0)
s_cmp_eq_u32 s53, 0
s_cbranch_scc0 a_35
s_mov_b64 exec, 1
ds_add_u32 v4, v5 offset:28
s_mov_b64 exec, -1
s_branch k2_34
a_35:
s_mov_b64 exec, 1
ds_add_u32 v4, v5 offset:32
s_mov_b64 exec, -1
s_branch k2_34
k1_33:
s_add_u32 s41, s40, 9216
v_add_u32 v28, s41, v28
s_cmp_eq_u32 s53, 0
s_cbranch_scc0 b_36
W_37:
ds_read_b32 v29, v4 offset:28
s_waitcnt lgkmcnt(0)
v_readfirstlane_b32 s39, v29
s_cmp_ge_u32 s39, 1
s_cbranch_scc1 D_38
s_sub_u32 s36, s36, 1
s_cbranch_scc0 W_37
s_mov_b32 s36, 0
D_38:
s_branch k3_39
b_36:
W_40:
ds_read_b32 v29, v4 offset:32
s_waitcnt lgkmcnt(0)
v_readfirstlane_b32 s39, v29
s_cmp_ge_u32 s39, 1
s_cbranch_scc1 D_41
s_sub_u32 s36, s36, 1
s_cbranch_scc0 W_40
s_mov_b32 s36, 0
D_41:
k3_39:
ds_read_b128 v[32:35], v28 offset:0
ds_read_b128 v[36:39], v28 offset:1024
ds_read_b128 v[40:43], v28 offset:2048
s_mul_i32 s41, s53, 1664
s_add_u32 s41, s41, 155776
v_lshlrev_b32 v14, 4, v1
v_lshl_add_u32 v14, v2, 3, v14
v_add_u32 v14, s41, v14
v_lshlrev_b32 v15, 3, v1
v_add_u32 v15, 512, v15
v_lshlrev_b32 v16, 2, v1
v_add_u32 v17, 896, v16
v_add_u32 v16, 768, v16
v_add_u32 v18, 4, v15
v_cndmask_b32 v15, v15, v16, s[54:55]
v_cndmask_b32 v16, v18, v17, s[54:55]
v_add_u32 v15, s41, v15
v_add_u32 v16, s41, v16
v_lshlrev_b32 v17, 1, v1
v_add_u32 v17, 1024, v17
v_mov_b32 v18, 1344
v_mov_b32 v19, 1280
v_cmp_eq_u32 vcc, 0, v1
s_nop 1
v_cndmask_b32 v18, v18, v19, vcc
v_cndmask_b32 v17, v17, v18, s[54:55]
v_add_u32 v17, s41, v17
v_mov_b32 v18, s41
v_mov_b32 v19, 0
ds_write_b32 v18, v19 offset:1288
s_waitcnt lgkmcnt(1)
v_add_f32 v192, v192, v32
v_add_f32 v193, v193, v33
v_add_f32 v194, v194, v34
v_add_f32 v195, v195, v35
v_add_f32 v196, v196, v36
v_add_f32 v197, v197, v37
v_add_f32 v198, v198, v38
v_add_f32 v199, v199, v39
v_add_f32 v200, v200, v40
v_add_f32 v201, v201, v41
v_add_f32 v202, v202, v42
v_add_f32 v203, v203, v43
v_cvt_pk_bf16_f32 v32, v192, v193
v_cvt_pk_bf16_f32 v33, v194, v195
v_cvt_pk_bf16_f32 v34, v196, v197
v_cvt_pk_bf16_f32 v35, v198, v199
v_cvt_pk_bf16_f32 v36, v200, v201
v_cvt_pk_bf16_f32 v37, v202, v203
ds_write_b16 v14, v32 offset:0
ds_write_b16_d16_hi v14, v32 offset:2
ds_write_b16 v14, v33 offset:4
ds_write_b16_d16_hi v14, v33 offset:6
ds_write_b16 v15, v34 offset:0
ds_write_b16_d16_hi v15, v34 offset:2
ds_write_b16 v16, v35 offset:0
ds_write_b16_d16_hi v16, v35 offset:2
ds_write_b16 v17, v36 offset:0
ds_write_b16_d16_hi v17, v36 offset:64
ds_write_b16 v17, v37 offset:128
ds_write_b16_d16_hi v17, v37 offset:192
s_waitcnt lgkmcnt(0)
s_mov_b64 exec, 1
ds_add_u32 v4, v5 offset:36
s_mov_b64 exec, -1
k2_34:
v_readfirstlane_b32 s37, v3
s_mul_i32 s37, s37, 1664525
s_add_u32 s37, s37, 1013904223
s_mul_i32 s38, s37, 0x2545F491
s_xor_b32 s38, s38, 0x5bd1e995
W_42:
ds_read_b32 v6, v4 offset:36
s_waitcnt lgkmcnt(0)
v_readfirstlane_b32 s39, v6
s_cmp_ge_u32 s39, 2
s_cbranch_scc1 D_43
s_sleep 2
s_sub_u32 s36, s36, 1
s_cbranch_scc0 W_42
s_mov_b32 s36, 0
D_43:
ds_read_u16 v128, v208 offset:0
ds_read_u16 v129, v209 offset:0
ds_read_u16 v130, v210 offset:0
ds_read_u16 v131, v211 offset:0
ds_read_u16 v132, v212 offset:0
ds_read_u16 v133, v213 offset:0
ds_read_u16 v134, v214 offset:0
ds_read_u16 v135, v215 offset:0
ds_read_u16 v136, v216 offset:0
ds_read_u16 v137, v217 offset:0
ds_read_u16 v138, v218 offset:0
ds_read_u16 v139, v219 offset:0
ds_read_u16 v140, v220 offset:0
ds_read_u16 v141, v221 offset:0
ds_read_u16 v142, v222 offset:0
ds_read_u16 v143, v223 offset:0
ds_read_u16 v144, v208 offset:1664
ds_read_u16 v145, v209 offset:1664
ds_read_u16 v146, v210 offset:1664
ds_read_u16 v147, v211 offset:1664
ds_read_u16 v148, v212 offset:1664
ds_read_u16 v149, v213 offset:1664
ds_read_u16 v150, v214 offset:1664
ds_read_u16 v151, v215 offset:1664
ds_read_u16 v152, v216 offset:1664
ds_read_u16 v153, v217 offset:1664
ds_read_u16 v154, v218 offset:1664
ds_read_u16 v155, v219 offset:1664
ds_read_u16 v156, v220 offset:1664
ds_read_u16 v157, v221 offset:1664
ds_read_u16 v158, v222 offset:1664
ds_read_u16 v159, v223 offset:1664
s_waitcnt lgkmcnt(15)
v_lshl_or_b32 v32, v129, 16, v128
v_lshl_or_b32 v33, v131, 16, v130
v_lshl_or_b32 v34, v133, 16, v132
v_lshl_or_b32 v35, v135, 16, v134
v_lshl_or_b32 v36, v137, 16, v136
v_lshl_or_b32 v37, v139, 16, v138
v_lshl_or_b32 v38, v141, 16, v140
v_lshl_or_b32 v39, v143, 16, v142
v_alignbit_b32 v40, v33, v32, 16
v_mov_b32 v48, v33
v_alignbit_b32 v56, v34, v33, 16
v_alignbit_b32 v41, v34, v33, 16
v_mov_b32 v49, v34
v_alignbit_b32 v57, v35, v34, 16
v_alignbit_b32 v42, v35, v34, 16
v_mov_b32 v50, v35
v_alignbit_b32 v58, v36, v35, 16
v_alignbit_b32 v43, v36, v35, 16
v_mov_b32 v51, v36
v_alignbit_b32 v59, v37, v36, 16
v_alignbit_b32 v44, v37, v36, 16
v_mov_b32 v52, v37
v_alignbit_b32 v60, v38, v37, 16
v_alignbit_b32 v45, v38, v37, 16
v_mov_b32 v53, v38
v_alignbit_b32 v61, v39, v38, 16
s_waitcnt lgkmcnt(0)
v_lshl_or_b32 v96, v145, 16, v144
v_lshl_or_b32 v97, v147, 16, v146
v_lshl_or_b32 v98, v149, 16, v148
v_lshl_or_b32 v99, v151, 16, v150
v_lshl_or_b32 v100, v153, 16, v152
v_lshl_or_b32 v101, v155, 16, v154
v_lshl_or_b32 v102, v157, 16, v156
v_lshl_or_b32 v103, v159, 16, v158
v_alignbit_b32 v104, v97, v96, 16
v_mov_b32 v112, v97
v_alignbit_b32 v120, v98, v97, 16
v_alignbit_b32 v105, v98, v97, 16
v_mov_b32 v113, v98
v_alignbit_b32 v121, v99, v98, 16
v_alignbit_b32 v106, v99, v98, 16
v_mov_b32 v114, v99
v_alignbit_b32 v122, v100, v99, 16
v_alignbit_b32 v107, v100, v99, 16
v_mov_b32 v115, v100
v_alignbit_b32 v123, v101, v100, 16
v_alignbit_b32 v108, v101, v100, 16
v_mov_b32 v116, v101
v_alignbit_b32 v124, v102, v101, 16
v_alignbit_b32 v109, v102, v101, 16
v_mov_b32 v117, v102
v_alignbit_b32 v125, v103, v102, 16
v_lshl_add_u32 v28, s52, 6, v0
v_mul_u32_u24 v28, 7168, v28
s_lshl_b32 s41, s59, 1
v_add_u32 v28, s41, v28
v_add_u32 v29, 3584, v28
global_load_dword v224, v28, s[4:5] offset:0
global_load_dword v225, v28, s[4:5] offset:896
global_load_dword v226, v28, s[4:5] offset:1792
global_load_dword v227, v28, s[4:5] offset:2688
global_load_dword v228, v29, s[4:5] offset:0
global_load_dword v229, v29, s[4:5] offset:896
global_load_dword v230, v29, s[4:5] offset:1792
global_load_dword v231, v29, s[4:5] offset:2688
s_cmp_eq_u32 s52, 1
s_cbranch_scc0 wp_44
v_min_u32 v28, 55, v0
s_and_b32 s42, s35, 7
s_mul_i32 s42, s42, 56
v_add_u32 v28, s42, v28
v_mul_u32_u24 v28, 896, v28
s_mul_i32 s42, s62, 224
v_add_u32 v28, s42, v28
global_load_dword v247, v28, s[22:23] offset:0
global_load_dword v247, v28, s[22:23] offset:112
global_load_dword v247, v28, s[22:23] offset:220
wp_44:
v_lshl_add_u32 v6, s52, 6, v0
v_mov_b32 v28, 0
v_mov_b32 v29, 0
v_mov_b32 v30, 0
v_mov_b32 v31, 0
v_lshlrev_b32 v7, 4, v6
v_add_u32 v8, 0, v7
v_add_u32 v7, 102400, v7
s_cmp_eq_u32 s52, 3
s_cbranch_scc0 z_45
v_bfe_u32 v13, v0, 2, 3
v_add_u32 v10, -1, v13
v_and_b32 v10, 3, v10
v_mul_u32_u24 v10, 3, v10
v_cmp_eq_u32 vcc, 0, v13
s_nop 1
v_cndmask_b32 v10, v10, v13, vcc
v_mul_u32_u24 v9, 273, v13
v_add_u32 v9, v9, v10
v_and_b32 v13, 3, v0
v_add_u32 v9, v9, v13
v_lshlrev_b32 v9, 4, v9
v_mov_b32 v13, 106496
v_mov_b32 v10, 4096
v_cndmask_b32 v13, v13, v10, s[54:55]
v_add_u32 v9, v9, v13
s_mov_b32 exec_hi, 0
ds_write_b128 v9, v[28:31]
s_mov_b32 exec_hi, -1
z_45:
ds_write_b128 v7, v[32:35] offset:4368
ds_write_b128 v7, v[40:43] offset:8784
ds_write_b128 v7, v[48:51] offset:13200
ds_write_b128 v7, v[56:59] offset:17616
ds_write_b128 v7, v[34:37] offset:21840
ds_write_b128 v7, v[42:45] offset:26256
ds_write_b128 v7, v[50:53] offset:30672
ds_write_b128 v7, v[58:61] offset:16
W_46:
ds_read_b32 v12, v4 offset:76
s_waitcnt lgkmcnt(0)
v_readfirstlane_b32 s39, v12
s_cmp_ge_u32 s39, 4
s_cbranch_scc1 D_47
s_sleep 2
s_sub_u32 s36, s36, 1
s_cbranch_scc0 W_46
s_mov_b32 s36, 0
D_47:
s_cmp_eq_u32 s52, 3
s_cbranch_scc0 z_48
s_mov_b32 exec_lo, 0
ds_write_b128 v9, v[28:31]
s_mov_b32 exec_lo, -1
z_48:
ds_write_b128 v8, v[96:99] offset:4368
ds_write_b128 v8, v[104:107] offset:8784
ds_write_b128 v8, v[112:115] offset:13200
ds_write_b128 v8, v[120:123] offset:17616
ds_write_b128 v8, v[98:101] offset:21840
ds_write_b128 v8, v[106:109] offset:26256
ds_write_b128 v8, v[114:117] offset:30672
ds_write_b128 v8, v[122:125] offset:16
v_lshlrev_b32 v7, 4, v6
v_add_u32 v7, 137472, v7
v_cmp_gt_u32 vcc, 160, v6
s_and_saveexec_b64 s[50:51], vcc
ds_write_b128 v7, v[28:31]
ds_write_b128 v7, v[28:31] offset:7680
s_mov_b64 exec, -1
v_lshrrev_b32 v7, 2, v6
v_mul_u32_u24 v7, 80, v7
v_and_b32 v8, 3, v6
v_lshlrev_b32 v8, 4, v8
v_add3_u32 v7, v7, v8, s63
s_mov_b32 s40, 0x05040100
s_mov_b32 s41, 0x07060302
s_waitcnt vmcnt(0)
v_perm_b32 v128, v225, v224, s40
v_perm_b32 v132, v225, v224, s41
v_perm_b32 v129, v227, v226, s40
v_perm_b32 v133, v227, v226, s41
v_perm_b32 v130, v229, v228, s40
v_perm_b32 v134, v229, v228, s41
v_perm_b32 v131, v231, v230, s40
v_perm_b32 v135, v231, v230, s41
ds_write_b128 v7, v[128:131]
ds_write_b128 v7, v[132:135] offset:7680
s_waitcnt lgkmcnt(0)
s_mov_b64 exec, 1
ds_add_u32 v4, v5 offset:40
s_mov_b64 exec, -1
W_49:
ds_read_b32 v6, v4 offset:40
s_waitcnt lgkmcnt(0)
v_readfirstlane_b32 s39, v6
s_cmp_ge_u32 s39, 4
s_cbranch_scc1 D_50
s_sleep 2
s_sub_u32 s36, s36, 1
s_cbranch_scc0 W_49
s_mov_b32 s36, 0
D_50:
v_sub_u32 v8, 0, v1
v_and_b32 v8, 7, v8
v_add_u32 v10, -1, v8
v_and_b32 v10, 3, v10
v_mul_u32_u24 v10, 3, v10
v_cmp_eq_u32 vcc, 0, v8
s_nop 1
v_cndmask_b32 v10, v10, v8, vcc
v_mul_u32_u24 v9, 273, v8
v_add_u32 v9, v9, v10
v_add_u32 v8, 7, v1
v_lshrrev_b32 v8, 3, v8
v_sub_u32 v9, v9, v8
v_add_u32 v9, v9, v2
s_lshl_b32 s40, s58, 1
s_add_u32 s40, s40, 256
v_add_u32 v9, s40, v9
v_lshlrev_b32 v9, 4, v9
s_mul_i32 s40, s53, 0xfffe7000
s_add_u32 s40, s40, 98368
v_add_u32 v9, s40, v9
v_add_u32 v8, 1, v1
v_mul_u32_u24 v8, 80, v8
v_lshl_add_u32 v8, v2, 4, v8
s_mul_i32 s40, s53, 7680
s_lshl_b32 s41, s58, 5
s_add_u32 s40, s40, s41
s_add_u32 s40, s40, 137472
v_add_u32 v8, s40, v8
ds_read_b128 v[64:67], v9 offset:4032
ds_read_b128 v[68:71], v8 offset:2480
ds_read_b128 v[72:75], v8 offset:5040
ds_read_b128 v[76:79], v9 offset:1984
ds_read_b128 v[80:83], v9 offset:3968
ds_read_b128 v[84:87], v8 offset:2400
ds_read_b128 v[88:91], v8 offset:4960
ds_read_b128 v[92:95], v9 offset:1920
ds_read_b128 v[96:99], v9 offset:3904
ds_read_b128 v[100:103], v8 offset:2320
ds_read_b128 v[104:107], v8 offset:4880
ds_read_b128 v[108:111], v9 offset:1856
s_waitcnt lgkmcnt(8)
v_mfma_f32_32x32x16_bf16 v[48:63], v[64:67], v[72:75], 0
v_mfma_f32_32x32x16_bf16 v[32:47], v[64:67], v[68:71], 0
v_mfma_f32_32x32x16_bf16 v[48:63], v[76:79], v[68:71], v[48:63]
ds_read_b128 v[64:67], v9 offset:3840
ds_read_b128 v[68:71], v8 offset:2240
ds_read_b128 v[72:75], v8 offset:4800
ds_read_b128 v[76:79], v9 offset:1792
s_waitcnt lgkmcnt(8)
v_mfma_f32_32x32x16_bf16 v[48:63], v[80:83], v[88:91], v[48:63]
v_mfma_f32_32x32x16_bf16 v[32:47], v[80:83], v[84:87], v[32:47]
v_mfma_f32_32x32x16_bf16 v[48:63], v[92:95], v[84:87], v[48:63]
ds_read_b128 v[80:83], v9 offset:3776
ds_read_b128 v[84:87], v8 offset:2160
ds_read_b128 v[88:91], v8 offset:4720
ds_read_b128 v[92:95], v9 offset:1728
s_waitcnt lgkmcnt(8)
v_mfma_f32_32x32x16_bf16 v[48:63], v[96:99], v[104:107], v[48:63]
v_mfma_f32_32x32x16_bf16 v[32:47], v[96:99], v[100:103], v[32:47]
v_mfma_f32_32x32x16_bf16 v[48:63], v[108:111], v[100:103], v[48:63]
ds_read_b128 v[96:99], v9 offset:3712
ds_read_b128 v[100:103], v8 offset:2080
ds_read_b128 v[104:107], v8 offset:4640
ds_read_b128 v[108:111], v9 offset:1664
s_waitcnt lgkmcnt(8)
v_mfma_f32_32x32x16_bf16 v[48:63], v[64:67], v[72:75], v[48:63]
v_mfma_f32_32x32x16_bf16 v[32:47], v[64:67], v[68:71], v[32:47]
v_mfma_f32_32x32x16_bf16 v[48:63], v[76:79], v[68:71], v[48:63]
ds_read_b128 v[64:67], v9 offset:3648
ds_read_b128 v[68:71], v8 offset:2000
ds_read_b128 v[72:75], v8 offset:4560
ds_read_b128 v[76:79], v9 offset:1600
s_waitcnt lgkmcnt(8)
v_mfma_f32_32x32x16_bf16 v[48:63], v[80:83], v[88:91], v[48:63]
v_mfma_f32_32x32x16_bf16 v[32:47], v[80:83], v[84:87], v[32:47]
v_mfma_f32_32x32x16_bf16 v[48:63], v[92:95], v[84:87], v[48:63]
ds_read_b128 v[80:83], v9 offset:3584
ds_read_b128 v[84:87], v8 offset:1920
ds_read_b128 v[88:91], v8 offset:4480
ds_read_b128 v[92:95], v9 offset:1536
s_waitcnt lgkmcnt(8)
v_mfma_f32_32x32x16_bf16 v[48:63], v[96:99], v[104:107], v[48:63]
v_mfma_f32_32x32x16_bf16 v[32:47], v[96:99], v[100:103], v[32:47]
v_mfma_f32_32x32x16_bf16 v[48:63], v[108:111], v[100:103], v[48:63]
ds_read_b128 v[96:99], v9 offset:3520
ds_read_b128 v[100:103], v8 offset:1840
ds_read_b128 v[104:107], v8 offset:4400
ds_read_b128 v[108:111], v9 offset:1472
s_waitcnt lgkmcnt(8)
v_mfma_f32_32x32x16_bf16 v[48:63], v[64:67], v[72:75], v[48:63]
v_mfma_f32_32x32x16_bf16 v[32:47], v[64:67], v[68:71], v[32:47]
v_mfma_f32_32x32x16_bf16 v[48:63], v[76:79], v[68:71], v[48:63]
ds_read_b128 v[64:67], v9 offset:3456
ds_read_b128 v[68:71], v8 offset:1760
ds_read_b128 v[72:75], v8 offset:4320
ds_read_b128 v[76:79], v9 offset:1408
s_waitcnt lgkmcnt(8)
v_mfma_f32_32x32x16_bf16 v[48:63], v[80:83], v[88:91], v[48:63]
v_mfma_f32_32x32x16_bf16 v[32:47], v[80:83], v[84:87], v[32:47]
v_mfma_f32_32x32x16_bf16 v[48:63], v[92:95], v[84:87], v[48:63]
ds_read_b128 v[80:83], v9 offset:3392
ds_read_b128 v[84:87], v8 offset:1680
ds_read_b128 v[88:91], v8 offset:4240
ds_read_b128 v[92:95], v9 offset:1344
s_waitcnt lgkmcnt(8)
v_mfma_f32_32x32x16_bf16 v[48:63], v[96:99], v[104:107], v[48:63]
v_mfma_f32_32x32x16_bf16 v[32:47], v[96:99], v[100:103], v[32:47]
v_mfma_f32_32x32x16_bf16 v[48:63], v[108:111], v[100:103], v[48:63]
ds_read_b128 v[96:99], v9 offset:3328
ds_read_b128 v[100:103], v8 offset:1600
ds_read_b128 v[104:107], v8 offset:4160
ds_read_b128 v[108:111], v9 offset:1280
s_waitcnt lgkmcnt(8)
v_mfma_f32_32x32x16_bf16 v[48:63], v[64:67], v[72:75], v[48:63]
v_mfma_f32_32x32x16_bf16 v[32:47], v[64:67], v[68:71], v[32:47]
v_mfma_f32_32x32x16_bf16 v[48:63], v[76:79], v[68:71], v[48:63]
ds_read_b128 v[64:67], v9 offset:3264
ds_read_b128 v[68:71], v8 offset:1520
ds_read_b128 v[72:75], v8 offset:4080
ds_read_b128 v[76:79], v9 offset:1216
s_waitcnt lgkmcnt(8)
v_mfma_f32_32x32x16_bf16 v[48:63], v[80:83], v[88:91], v[48:63]
v_mfma_f32_32x32x16_bf16 v[32:47], v[80:83], v[84:87], v[32:47]
v_mfma_f32_32x32x16_bf16 v[48:63], v[92:95], v[84:87], v[48:63]
ds_read_b128 v[80:83], v9 offset:3200
ds_read_b128 v[84:87], v8 offset:1440
ds_read_b128 v[88:91], v8 offset:4000
ds_read_b128 v[92:95], v9 offset:1152
s_waitcnt lgkmcnt(8)
v_mfma_f32_32x32x16_bf16 v[48:63], v[96:99], v[104:107], v[48:63]
v_mfma_f32_32x32x16_bf16 v[32:47], v[96:99], v[100:103], v[32:47]
v_mfma_f32_32x32x16_bf16 v[48:63], v[108:111], v[100:103], v[48:63]
ds_read_b128 v[96:99], v9 offset:3136
ds_read_b128 v[100:103], v8 offset:1360
ds_read_b128 v[104:107], v8 offset:3920
ds_read_b128 v[108:111], v9 offset:1088
s_waitcnt lgkmcnt(8)
v_mfma_f32_32x32x16_bf16 v[48:63], v[64:67], v[72:75], v[48:63]
v_mfma_f32_32x32x16_bf16 v[32:47], v[64:67], v[68:71], v[32:47]
v_mfma_f32_32x32x16_bf16 v[48:63], v[76:79], v[68:71], v[48:63]
ds_read_b128 v[64:67], v9 offset:3072
ds_read_b128 v[68:71], v8 offset:1280
ds_read_b128 v[72:75], v8 offset:3840
ds_read_b128 v[76:79], v9 offset:1024
s_waitcnt lgkmcnt(8)
v_mfma_f32_32x32x16_bf16 v[48:63], v[80:83], v[88:91], v[48:63]
v_mfma_f32_32x32x16_bf16 v[32:47], v[80:83], v[84:87], v[32:47]
v_mfma_f32_32x32x16_bf16 v[48:63], v[92:95], v[84:87], v[48:63]
ds_read_b128 v[80:83], v9 offset:3008
ds_read_b128 v[84:87], v8 offset:1200
ds_read_b128 v[88:91], v8 offset:3760
ds_read_b128 v[92:95], v9 offset:960
s_waitcnt lgkmcnt(8)
v_mfma_f32_32x32x16_bf16 v[48:63], v[96:99], v[104:107], v[48:63]
v_mfma_f32_32x32x16_bf16 v[32:47], v[96:99], v[100:103], v[32:47]
v_mfma_f32_32x32x16_bf16 v[48:63], v[108:111], v[100:103], v[48:63]
ds_read_b128 v[96:99], v9 offset:2944
ds_read_b128 v[100:103], v8 offset:1120
ds_read_b128 v[104:107], v8 offset:3680
ds_read_b128 v[108:111], v9 offset:896
s_waitcnt lgkmcnt(8)
v_mfma_f32_32x32x16_bf16 v[48:63], v[64:67], v[72:75], v[48:63]
v_mfma_f32_32x32x16_bf16 v[32:47], v[64:67], v[68:71], v[32:47]
v_mfma_f32_32x32x16_bf16 v[48:63], v[76:79], v[68:71], v[48:63]
ds_read_b128 v[64:67], v9 offset:2880
ds_read_b128 v[68:71], v8 offset:1040
ds_read_b128 v[72:75], v8 offset:3600
ds_read_b128 v[76:79], v9 offset:832
s_waitcnt lgkmcnt(8)
v_mfma_f32_32x32x16_bf16 v[48:63], v[80:83], v[88:91], v[48:63]
v_mfma_f32_32x32x16_bf16 v[32:47], v[80:83], v[84:87], v[32:47]
v_mfma_f32_32x32x16_bf16 v[48:63], v[92:95], v[84:87], v[48:63]
ds_read_b128 v[80:83], v9 offset:2816
ds_read_b128 v[84:87], v8 offset:960
ds_read_b128 v[88:91], v8 offset:3520
ds_read_b128 v[92:95], v9 offset:768
s_waitcnt lgkmcnt(8)
v_mfma_f32_32x32x16_bf16 v[48:63], v[96:99], v[104:107], v[48:63]
v_mfma_f32_32x32x16_bf16 v[32:47], v[96:99], v[100:103], v[32:47]
v_mfma_f32_32x32x16_bf16 v[48:63], v[108:111], v[100:103], v[48:63]
ds_read_b128 v[96:99], v9 offset:2752
ds_read_b128 v[100:103], v8 offset:880
ds_read_b128 v[104:107], v8 offset:3440
ds_read_b128 v[108:111], v9 offset:704
s_waitcnt lgkmcnt(8)
v_mfma_f32_32x32x16_bf16 v[48:63], v[64:67], v[72:75], v[48:63]
v_mfma_f32_32x32x16_bf16 v[32:47], v[64:67], v[68:71], v[32:47]
v_mfma_f32_32x32x16_bf16 v[48:63], v[76:79], v[68:71], v[48:63]
ds_read_b128 v[64:67], v9 offset:2688
ds_read_b128 v[68:71], v8 offset:800
ds_read_b128 v[72:75], v8 offset:3360
ds_read_b128 v[76:79], v9 offset:640
s_waitcnt lgkmcnt(8)
v_mfma_f32_32x32x16_bf16 v[48:63], v[80:83], v[88:91], v[48:63]
v_mfma_f32_32x32x16_bf16 v[32:47], v[80:83], v[84:87], v[32:47]
v_mfma_f32_32x32x16_bf16 v[48:63], v[92:95], v[84:87], v[48:63]
ds_read_b128 v[80:83], v9 offset:2624
ds_read_b128 v[84:87], v8 offset:720
ds_read_b128 v[88:91], v8 offset:3280
ds_read_b128 v[92:95], v9 offset:576
s_waitcnt lgkmcnt(8)
v_mfma_f32_32x32x16_bf16 v[48:63], v[96:99], v[104:107], v[48:63]
v_mfma_f32_32x32x16_bf16 v[32:47], v[96:99], v[100:103], v[32:47]
v_mfma_f32_32x32x16_bf16 v[48:63], v[108:111], v[100:103], v[48:63]
ds_read_b128 v[96:99], v9 offset:2560
ds_read_b128 v[100:103], v8 offset:640
ds_read_b128 v[104:107], v8 offset:3200
ds_read_b128 v[108:111], v9 offset:512
s_waitcnt lgkmcnt(8)
v_mfma_f32_32x32x16_bf16 v[48:63], v[64:67], v[72:75], v[48:63]
v_mfma_f32_32x32x16_bf16 v[32:47], v[64:67], v[68:71], v[32:47]
v_mfma_f32_32x32x16_bf16 v[48:63], v[76:79], v[68:71], v[48:63]
ds_read_b128 v[64:67], v9 offset:2496
ds_read_b128 v[68:71], v8 offset:560
ds_read_b128 v[72:75], v8 offset:3120
ds_read_b128 v[76:79], v9 offset:448
s_waitcnt lgkmcnt(8)
v_mfma_f32_32x32x16_bf16 v[48:63], v[80:83], v[88:91], v[48:63]
v_mfma_f32_32x32x16_bf16 v[32:47], v[80:83], v[84:87], v[32:47]
v_mfma_f32_32x32x16_bf16 v[48:63], v[92:95], v[84:87], v[48:63]
ds_read_b128 v[80:83], v9 offset:2432
ds_read_b128 v[84:87], v8 offset:480
ds_read_b128 v[88:91], v8 offset:3040
ds_read_b128 v[92:95], v9 offset:384
s_waitcnt lgkmcnt(8)
v_mfma_f32_32x32x16_bf16 v[48:63], v[96:99], v[104:107], v[48:63]
v_mfma_f32_32x32x16_bf16 v[32:47], v[96:99], v[100:103], v[32:47]
v_mfma_f32_32x32x16_bf16 v[48:63], v[108:111], v[100:103], v[48:63]
ds_read_b128 v[96:99], v9 offset:2368
ds_read_b128 v[100:103], v8 offset:400
ds_read_b128 v[104:107], v8 offset:2960
ds_read_b128 v[108:111], v9 offset:320
s_waitcnt lgkmcnt(8)
v_mfma_f32_32x32x16_bf16 v[48:63], v[64:67], v[72:75], v[48:63]
v_mfma_f32_32x32x16_bf16 v[32:47], v[64:67], v[68:71], v[32:47]
v_mfma_f32_32x32x16_bf16 v[48:63], v[76:79], v[68:71], v[48:63]
ds_read_b128 v[64:67], v9 offset:2304
ds_read_b128 v[68:71], v8 offset:320
ds_read_b128 v[72:75], v8 offset:2880
ds_read_b128 v[76:79], v9 offset:256
s_waitcnt lgkmcnt(8)
v_mfma_f32_32x32x16_bf16 v[48:63], v[80:83], v[88:91], v[48:63]
v_mfma_f32_32x32x16_bf16 v[32:47], v[80:83], v[84:87], v[32:47]
v_mfma_f32_32x32x16_bf16 v[48:63], v[92:95], v[84:87], v[48:63]
ds_read_b128 v[80:83], v9 offset:2240
ds_read_b128 v[84:87], v8 offset:240
ds_read_b128 v[88:91], v8 offset:2800
ds_read_b128 v[92:95], v9 offset:192
s_waitcnt lgkmcnt(8)
v_mfma_f32_32x32x16_bf16 v[48:63], v[96:99], v[104:107], v[48:63]
v_mfma_f32_32x32x16_bf16 v[32:47], v[96:99], v[100:103], v[32:47]
v_mfma_f32_32x32x16_bf16 v[48:63], v[108:111], v[100:103], v[48:63]
ds_read_b128 v[96:99], v9 offset:2176
ds_read_b128 v[100:103], v8 offset:160
ds_read_b128 v[104:107], v8 offset:2720
ds_read_b128 v[108:111], v9 offset:128
s_waitcnt lgkmcnt(8)
v_mfma_f32_32x32x16_bf16 v[48:63], v[64:67], v[72:75], v[48:63]
v_mfma_f32_32x32x16_bf16 v[32:47], v[64:67], v[68:71], v[32:47]
v_mfma_f32_32x32x16_bf16 v[48:63], v[76:79], v[68:71], v[48:63]
ds_read_b128 v[64:67], v9 offset:2112
ds_read_b128 v[68:71], v8 offset:80
ds_read_b128 v[72:75], v8 offset:2640
ds_read_b128 v[76:79], v9 offset:64
s_waitcnt lgkmcnt(8)
v_mfma_f32_32x32x16_bf16 v[48:63], v[80:83], v[88:91], v[48:63]
v_mfma_f32_32x32x16_bf16 v[32:47], v[80:83], v[84:87], v[32:47]
v_mfma_f32_32x32x16_bf16 v[48:63], v[92:95], v[84:87], v[48:63]
ds_read_b128 v[80:83], v9 offset:2048
ds_read_b128 v[84:87], v8 offset:0
ds_read_b128 v[88:91], v8 offset:2560
ds_read_b128 v[92:95], v9 offset:0
s_waitcnt lgkmcnt(8)
v_mfma_f32_32x32x16_bf16 v[48:63], v[96:99], v[104:107], v[48:63]
v_mfma_f32_32x32x16_bf16 v[32:47], v[96:99], v[100:103], v[32:47]
v_mfma_f32_32x32x16_bf16 v[48:63], v[108:111], v[100:103], v[48:63]
s_waitcnt lgkmcnt(4)
v_mfma_f32_32x32x16_bf16 v[48:63], v[64:67], v[72:75], v[48:63]
v_mfma_f32_32x32x16_bf16 v[32:47], v[64:67], v[68:71], v[32:47]
v_mfma_f32_32x32x16_bf16 v[48:63], v[76:79], v[68:71], v[48:63]
s_waitcnt lgkmcnt(0)
v_mfma_f32_32x32x16_bf16 v[48:63], v[80:83], v[88:91], v[48:63]
v_mfma_f32_32x32x16_bf16 v[32:47], v[80:83], v[84:87], v[32:47]
v_mfma_f32_32x32x16_bf16 v[48:63], v[92:95], v[84:87], v[48:63]
s_nop 7
s_nop 7
s_cmp_eq_u32 s58, 0
s_cbranch_scc1 sw_51
v_swap_b32 v32, v48
v_swap_b32 v33, v49
v_swap_b32 v34, v50
v_swap_b32 v35, v51
v_swap_b32 v36, v52
v_swap_b32 v37, v53
v_swap_b32 v38, v54
v_swap_b32 v39, v55
v_swap_b32 v40, v56
v_swap_b32 v41, v57
v_swap_b32 v42, v58
v_swap_b32 v43, v59
v_swap_b32 v44, v60
v_swap_b32 v45, v61
v_swap_b32 v46, v62
v_swap_b32 v47, v63
sw_51:
s_lshl_b32 s40, s52, 12
s_add_u32 s40, s40, 36864
s_cmp_eq_u32 s52, 3
s_cselect_b32 s40, 159552, s40
s_xor_b32 s41, s52, 1
s_lshl_b32 s42, s41, 12
s_add_u32 s42, s42, 36864
s_cmp_eq_u32 s41, 3
s_cselect_b32 s41, 159552, s42
v_lshlrev_b32 v10, 4, v0
v_add_u32 v11, s40, v10
v_add_u32 v10, s41, v10
s_mul_i32 s40, s53, 7680
s_mul_i32 s41, s58, 2560
s_add_u32 s40, s40, s41
s_add_u32 s40, s40, 140032
v_mul_u32_u24 v8, 80, v1
v_lshl_add_u32 v8, v2, 3, v8
v_add_u32 v8, s40, v8
ds_read_b64 v[64:65], v8 offset:0
ds_read_b64 v[66:67], v8 offset:16
ds_read_b64 v[68:69], v8 offset:32
ds_read_b64 v[70:71], v8 offset:48
W_52:
ds_read_b32 v12, v4 offset:16
s_waitcnt lgkmcnt(0)
v_readfirstlane_b32 s39, v12
s_cmp_ge_u32 s39, 4
s_cbranch_scc1 D_53
s_sleep 2
s_sub_u32 s36, s36, 1
s_cbranch_scc0 W_52
s_mov_b32 s36, 0
D_53:
ds_write_b128 v11, v[48:51] offset:0
ds_write_b128 v11, v[52:55] offset:1024
ds_write_b128 v11, v[56:59] offset:2048
ds_write_b128 v11, v[60:63] offset:3072
s_waitcnt lgkmcnt(0)
s_mov_b64 exec, 1
ds_add_u32 v4, v5 offset:44
s_mov_b64 exec, -1
s_mov_b32 s44, s22
s_mov_b32 s45, s23
s_mov_b32 s46, 401408
s_mov_b32 s47, 0x20000
s_add_u32 s42, s52, 0
s_mul_i32 s48, s42, 7168
s_add_u32 s48, s48, 49152
s_add_u32 s42, s42, 0
s_mul_i32 s43, s42, 28672
s_add_u32 m0, s48, 0
s_nop 0
buffer_load_dwordx4 v240, s[44:47], s43 offen lds
s_add_u32 m0, s48, 1024
s_nop 0
buffer_load_dwordx4 v241, s[44:47], s43 offen lds
s_add_u32 m0, s48, 2048
s_nop 0
buffer_load_dwordx4 v242, s[44:47], s43 offen lds
s_add_u32 m0, s48, 3072
s_nop 0
buffer_load_dwordx4 v243, s[44:47], s43 offen lds
s_add_u32 m0, s48, 4096
s_nop 0
buffer_load_dwordx4 v244, s[44:47], s43 offen lds
s_add_u32 m0, s48, 5120
s_nop 0
buffer_load_dwordx4 v245, s[44:47], s43 offen lds
s_add_u32 m0, s48, 6144
s_nop 0
buffer_load_dwordx4 v246, s[44:47], s43 offen lds
g_54:
s_add_u32 s42, s52, 4
s_cmp_lt_u32 s42, 7
s_cbranch_scc0 g_55
s_mul_i32 s48, s42, 7168
s_add_u32 s48, s48, 49152
s_add_u32 s42, s42, 0
s_mul_i32 s43, s42, 28672
s_add_u32 m0, s48, 0
s_nop 0
buffer_load_dwordx4 v240, s[44:47], s43 offen lds
s_add_u32 m0, s48, 1024
s_nop 0
buffer_load_dwordx4 v241, s[44:47], s43 offen lds
s_add_u32 m0, s48, 2048
s_nop 0
buffer_load_dwordx4 v242, s[44:47], s43 offen lds
s_add_u32 m0, s48, 3072
s_nop 0
buffer_load_dwordx4 v243, s[44:47], s43 offen lds
s_add_u32 m0, s48, 4096
s_nop 0
buffer_load_dwordx4 v244, s[44:47], s43 offen lds
s_add_u32 m0, s48, 5120
s_nop 0
buffer_load_dwordx4 v245, s[44:47], s43 offen lds
s_add_u32 m0, s48, 6144
s_nop 0
buffer_load_dwordx4 v246, s[44:47], s43 offen lds
g_55:
W_56:
ds_read_b32 v12, v4 offset:44
s_waitcnt lgkmcnt(0)
v_readfirstlane_b32 s39, v12
s_cmp_ge_u32 s39, 4
s_cbranch_scc1 D_57
s_sleep 1
s_sub_u32 s36, s36, 1
s_cbranch_scc0 W_56
s_mov_b32 s36, 0
D_57:
ds_read_b128 v[48:51], v10 offset:0
ds_read_b128 v[52:55], v10 offset:1024
ds_read_b128 v[56:59], v10 offset:2048
ds_read_b128 v[60:63], v10 offset:3072
s_lshl_b32 s40, s60, 12
s_lshl_b32 s41, s58, 11
s_add_u32 s40, s40, s41
s_add_u32 s40, s40, 12582912
v_lshlrev_b32 v9, 6, v1
v_lshl_add_u32 v9, v2, 3, v9
v_add_u32 v9, s40, v9
v_mov_b32 v234, v233
s_waitcnt lgkmcnt(0)
v_pk_add_f32 v[32:33], v[32:33], v[48:49]
v_pk_add_f32 v[34:35], v[34:35], v[50:51]
v_pk_add_f32 v[36:37], v[36:37], v[52:53]
v_pk_add_f32 v[38:39], v[38:39], v[54:55]
v_pk_add_f32 v[40:41], v[40:41], v[56:57]
v_pk_add_f32 v[42:43], v[42:43], v[58:59]
v_pk_add_f32 v[44:45], v[44:45], v[60:61]
v_pk_add_f32 v[46:47], v[46:47], v[62:63]
v_and_b32 v49, 0xffff0000, v64
v_lshlrev_b32 v48, 16, v64
v_and_b32 v51, 0xffff0000, v65
v_lshlrev_b32 v50, 16, v65
v_and_b32 v53, 0xffff0000, v66
v_lshlrev_b32 v52, 16, v66
v_and_b32 v55, 0xffff0000, v67
v_lshlrev_b32 v54, 16, v67
v_and_b32 v57, 0xffff0000, v68
v_lshlrev_b32 v56, 16, v68
v_and_b32 v59, 0xffff0000, v69
v_lshlrev_b32 v58, 16, v69
v_and_b32 v61, 0xffff0000, v70
v_lshlrev_b32 v60, 16, v70
v_and_b32 v63, 0xffff0000, v71
v_lshlrev_b32 v62, 16, v71
v_pk_fma_f32 v[32:33], v[48:49], v[234:235], v[32:33] op_sel_hi:[1,0,1]
v_pk_fma_f32 v[34:35], v[50:51], v[234:235], v[34:35] op_sel_hi:[1,0,1]
v_pk_fma_f32 v[36:37], v[52:53], v[234:235], v[36:37] op_sel_hi:[1,0,1]
v_pk_fma_f32 v[38:39], v[54:55], v[234:235], v[38:39] op_sel_hi:[1,0,1]
v_pk_fma_f32 v[40:41], v[56:57], v[234:235], v[40:41] op_sel_hi:[1,0,1]
v_pk_fma_f32 v[42:43], v[58:59], v[234:235], v[42:43] op_sel_hi:[1,0,1]
v_pk_fma_f32 v[44:45], v[60:61], v[234:235], v[44:45] op_sel_hi:[1,0,1]
v_pk_fma_f32 v[46:47], v[62:63], v[234:235], v[46:47] op_sel_hi:[1,0,1]
v_cvt_pk_bf16_f32 v64, v32, v33
v_cvt_pk_bf16_f32 v65, v34, v35
v_cvt_pk_bf16_f32 v66, v36, v37
v_cvt_pk_bf16_f32 v67, v38, v39
v_cvt_pk_bf16_f32 v68, v40, v41
v_cvt_pk_bf16_f32 v69, v42, v43
v_cvt_pk_bf16_f32 v70, v44, v45
v_cvt_pk_bf16_f32 v71, v46, v47
global_store_dwordx2 v9, v[64:65], s[30:31] offset:0 sc1
global_store_dwordx2 v9, v[66:67], s[30:31] offset:16 sc1
global_store_dwordx2 v9, v[68:69], s[30:31] offset:32 sc1
global_store_dwordx2 v9, v[70:71], s[30:31] offset:48 sc1
s_mov_b32 s44, s22
s_mov_b32 s45, s23
s_mov_b32 s46, 401408
s_mov_b32 s47, 0x20000
s_add_u32 s42, s52, 0
s_mul_i32 s48, s42, 7168
s_add_u32 s48, s48, 102400
s_add_u32 s42, s42, 7
s_mul_i32 s43, s42, 28672
s_add_u32 m0, s48, 0
s_nop 0
buffer_load_dwordx4 v240, s[44:47], s43 offen lds
s_add_u32 m0, s48, 1024
s_nop 0
buffer_load_dwordx4 v241, s[44:47], s43 offen lds
s_add_u32 m0, s48, 2048
s_nop 0
buffer_load_dwordx4 v242, s[44:47], s43 offen lds
s_add_u32 m0, s48, 3072
s_nop 0
buffer_load_dwordx4 v243, s[44:47], s43 offen lds
s_add_u32 m0, s48, 4096
s_nop 0
buffer_load_dwordx4 v244, s[44:47], s43 offen lds
s_add_u32 m0, s48, 5120
s_nop 0
buffer_load_dwordx4 v245, s[44:47], s43 offen lds
s_add_u32 m0, s48, 6144
s_nop 0
buffer_load_dwordx4 v246, s[44:47], s43 offen lds
g_58:
s_add_u32 s42, s52, 4
s_cmp_lt_u32 s42, 7
s_cbranch_scc0 g_59
s_mul_i32 s48, s42, 7168
s_add_u32 s48, s48, 102400
s_add_u32 s42, s42, 7
s_mul_i32 s43, s42, 28672
s_add_u32 m0, s48, 0
s_nop 0
buffer_load_dwordx4 v240, s[44:47], s43 offen lds
s_add_u32 m0, s48, 1024
s_nop 0
buffer_load_dwordx4 v241, s[44:47], s43 offen lds
s_add_u32 m0, s48, 2048
s_nop 0
buffer_load_dwordx4 v242, s[44:47], s43 offen lds
s_add_u32 m0, s48, 3072
s_nop 0
buffer_load_dwordx4 v243, s[44:47], s43 offen lds
s_add_u32 m0, s48, 4096
s_nop 0
buffer_load_dwordx4 v244, s[44:47], s43 offen lds
s_add_u32 m0, s48, 5120
s_nop 0
buffer_load_dwordx4 v245, s[44:47], s43 offen lds
s_add_u32 m0, s48, 6144
s_nop 0
buffer_load_dwordx4 v246, s[44:47], s43 offen lds
g_59:
s_cmp_eq_u32 s52, 3
s_cbranch_scc1 s4_61
s_waitcnt vmcnt(14)
s_branch s5_62
s4_61:
s_waitcnt vmcnt(7)
s5_62:
s_mov_b64 exec, 1
ds_add_rtn_u32 v6, v4, v5 offset:48
s_mov_b64 exec, -1
s_waitcnt lgkmcnt(0)
v_readfirstlane_b32 s39, v6
s_cmp_eq_u32 s39, 3
s_cbranch_scc0 sk_60
s_mul_i32 s40, s34, 28
s_add_u32 s40, s40, s35
s_lshl_b32 s40, s40, 3
s_add_u32 s40, s40, 20480
v_mov_b32 v6, s40
v_mov_b32 v8, s37
v_mov_b32 v9, s38
s_mov_b64 exec, 1
global_store_dwordx2 v6, v[8:9], s[30:31] sc1
s_mov_b64 exec, -1
sk_60:
W_63:
ds_read_b32 v6, v4 offset:48
s_waitcnt lgkmcnt(0)
v_readfirstlane_b32 s39, v6
s_cmp_ge_u32 s39, 4
s_cbranch_scc1 D_64
s_sleep 1
s_sub_u32 s36, s36, 1
s_cbranch_scc0 W_63
s_mov_b32 s36, 0
D_64:
v_lshrrev_b32 v14, 2, v0
v_and_b32 v14, 3, v14
v_lshl_add_u32 v14, v2, 2, v14
v_mul_u32_u24 v14, 224, v14
v_bfe_u32 v13, v0, 4, 1
v_lshlrev_b32 v13, 5, v13
v_and_b32 v12, 3, v0
v_lshlrev_b32 v12, 3, v12
v_add3_u32 v14, v14, v13, v12
s_mul_i32 s40, s52, 56
s_add_u32 s40, s40, 49152
v_add_u32 v14, s40, v14
ds_read_b64_tr_b16 v[128:129], v14 offset:0
ds_read_b64_tr_b16 v[130:131], v14 offset:1792
ds_read_b64_tr_b16 v[132:133], v14 offset:3584
ds_read_b64_tr_b16 v[134:135], v14 offset:5376
ds_read_b64_tr_b16 v[136:137], v14 offset:6272
ds_read_b64_tr_b16 v[138:139], v14 offset:8064
ds_read_b64_tr_b16 v[140:141], v14 offset:9856
ds_read_b64_tr_b16 v[142:143], v14 offset:11648
ds_read_b64_tr_b16 v[144:145], v14 offset:12544
ds_read_b64_tr_b16 v[146:147], v14 offset:14336
ds_read_b64_tr_b16 v[148:149], v14 offset:16128
ds_read_b64_tr_b16 v[150:151], v14 offset:17920
ds_read_b64_tr_b16 v[152:153], v14 offset:18816
ds_read_b64_tr_b16 v[154:155], v14 offset:20608
ds_read_b64_tr_b16 v[156:157], v14 offset:22400
ds_read_b64_tr_b16 v[158:159], v14 offset:24192
ds_read_b64_tr_b16 v[160:161], v14 offset:25088
ds_read_b64_tr_b16 v[162:163], v14 offset:26880
ds_read_b64_tr_b16 v[164:165], v14 offset:28672
ds_read_b64_tr_b16 v[166:167], v14 offset:30464
ds_read_b64_tr_b16 v[168:169], v14 offset:31360
ds_read_b64_tr_b16 v[170:171], v14 offset:33152
ds_read_b64_tr_b16 v[172:173], v14 offset:34944
ds_read_b64_tr_b16 v[174:175], v14 offset:36736
ds_read_b64_tr_b16 v[176:177], v14 offset:37632
ds_read_b64_tr_b16 v[178:179], v14 offset:39424
ds_read_b64_tr_b16 v[180:181], v14 offset:41216
ds_read_b64_tr_b16 v[182:183], v14 offset:43008
ds_read_b64_tr_b16 v[184:185], v14 offset:43904
ds_read_b64_tr_b16 v[186:187], v14 offset:45696
ds_read_b64_tr_b16 v[188:189], v14 offset:47488
ds_read_b64_tr_b16 v[190:191], v14 offset:49280
s_waitcnt lgkmcnt(0)
s_mov_b64 exec, 1
ds_add_u32 v4, v5 offset:56
s_mov_b64 exec, -1
v_mov_b32 v12, 0
v_cndmask_b32 v190, v190, v12, s[54:55]
v_cndmask_b32 v191, v191, v12, s[54:55]
s_branch SFIN
SNOSSM:
s_barrier
s_mul_i32 s41, s62, 224
v_add_u32 v6, 0, v0
v_mul_u32_u24 v7, 0x4925, v6
v_lshrrev_b32 v7, 18, v7
v_mul_u32_u24 v12, 14, v7
v_sub_u32 v6, v6, v12
v_lshlrev_b32 v6, 4, v6
v_mul_u32_u24 v7, 896, v7
v_add3_u32 v240, v6, v7, s41
v_add_u32 v6, 64, v0
v_mul_u32_u24 v7, 0x4925, v6
v_lshrrev_b32 v7, 18, v7
v_mul_u32_u24 v12, 14, v7
v_sub_u32 v6, v6, v12
v_lshlrev_b32 v6, 4, v6
v_mul_u32_u24 v7, 896, v7
v_add3_u32 v241, v6, v7, s41
v_add_u32 v6, 128, v0
v_mul_u32_u24 v7, 0x4925, v6
v_lshrrev_b32 v7, 18, v7
v_mul_u32_u24 v12, 14, v7
v_sub_u32 v6, v6, v12
v_lshlrev_b32 v6, 4, v6
v_mul_u32_u24 v7, 896, v7
v_add3_u32 v242, v6, v7, s41
v_add_u32 v6, 192, v0
v_mul_u32_u24 v7, 0x4925, v6
v_lshrrev_b32 v7, 18, v7
v_mul_u32_u24 v12, 14, v7
v_sub_u32 v6, v6, v12
v_lshlrev_b32 v6, 4, v6
v_mul_u32_u24 v7, 896, v7
v_add3_u32 v243, v6, v7, s41
v_add_u32 v6, 256, v0
v_mul_u32_u24 v7, 0x4925, v6
v_lshrrev_b32 v7, 18, v7
v_mul_u32_u24 v12, 14, v7
v_sub_u32 v6, v6, v12
v_lshlrev_b32 v6, 4, v6
v_mul_u32_u24 v7, 896, v7
v_add3_u32 v244, v6, v7, s41
v_add_u32 v6, 320, v0
v_mul_u32_u24 v7, 0x4925, v6
v_lshrrev_b32 v7, 18, v7
v_mul_u32_u24 v12, 14, v7
v_sub_u32 v6, v6, v12
v_lshlrev_b32 v6, 4, v6
v_mul_u32_u24 v7, 896, v7
v_add3_u32 v245, v6, v7, s41
v_add_u32 v6, 384, v0
v_mul_u32_u24 v7, 0x4925, v6
v_lshrrev_b32 v7, 18, v7
v_mul_u32_u24 v12, 14, v7
v_sub_u32 v6, v6, v12
v_lshlrev_b32 v6, 4, v6
v_mul_u32_u24 v7, 896, v7
v_add3_u32 v246, v6, v7, s41
s_waitcnt vmcnt(0)
s_mov_b64 exec, 1
ds_add_u32 v4, v5 offset:24
s_mov_b64 exec, -1
s_cmp_eq_u32 s52, 1
s_cbranch_scc0 wp_65
v_min_u32 v28, 55, v0
s_and_b32 s42, s35, 7
s_mul_i32 s42, s42, 56
v_add_u32 v28, s42, v28
v_mul_u32_u24 v28, 896, v28
s_mul_i32 s42, s62, 224
v_add_u32 v28, s42, v28
global_load_dword v247, v28, s[22:23] offset:0
global_load_dword v247, v28, s[22:23] offset:112
global_load_dword v247, v28, s[22:23] offset:220
wp_65:
v_readfirstlane_b32 s37, v3
s_mul_i32 s37, s37, 1664525
s_add_u32 s37, s37, 1013904223
s_mul_i32 s38, s37, 0x2545F491
s_xor_b32 s38, s38, 0x5bd1e995
W_66:
ds_read_b32 v6, v4 offset:16
s_waitcnt lgkmcnt(0)
v_readfirstlane_b32 s39, v6
s_cmp_ge_u32 s39, 4
s_cbranch_scc1 D_67
s_sleep 8
s_sub_u32 s36, s36, 1
s_cbranch_scc0 W_66
s_mov_b32 s36, 0
D_67:
s_mov_b32 s44, s22
s_mov_b32 s45, s23
s_mov_b32 s46, 401408
s_mov_b32 s47, 0x20000
s_add_u32 s42, s52, 0
s_mul_i32 s48, s42, 7168
s_add_u32 s48, s48, 49152
s_add_u32 s42, s42, 0
s_mul_i32 s43, s42, 28672
s_add_u32 m0, s48, 0
s_nop 0
buffer_load_dwordx4 v240, s[44:47], s43 offen lds
s_add_u32 m0, s48, 1024
s_nop 0
buffer_load_dwordx4 v241, s[44:47], s43 offen lds
s_add_u32 m0, s48, 2048
s_nop 0
buffer_load_dwordx4 v242, s[44:47], s43 offen lds
s_add_u32 m0, s48, 3072
s_nop 0
buffer_load_dwordx4 v243, s[44:47], s43 offen lds
s_add_u32 m0, s48, 4096
s_nop 0
buffer_load_dwordx4 v244, s[44:47], s43 offen lds
s_add_u32 m0, s48, 5120
s_nop 0
buffer_load_dwordx4 v245, s[44:47], s43 offen lds
s_add_u32 m0, s48, 6144
s_nop 0
buffer_load_dwordx4 v246, s[44:47], s43 offen lds
g_68:
s_add_u32 s42, s52, 4
s_cmp_lt_u32 s42, 7
s_cbranch_scc0 g_69
s_mul_i32 s48, s42, 7168
s_add_u32 s48, s48, 49152
s_add_u32 s42, s42, 0
s_mul_i32 s43, s42, 28672
s_add_u32 m0, s48, 0
s_nop 0
buffer_load_dwordx4 v240, s[44:47], s43 offen lds
s_add_u32 m0, s48, 1024
s_nop 0
buffer_load_dwordx4 v241, s[44:47], s43 offen lds
s_add_u32 m0, s48, 2048
s_nop 0
buffer_load_dwordx4 v242, s[44:47], s43 offen lds
s_add_u32 m0, s48, 3072
s_nop 0
buffer_load_dwordx4 v243, s[44:47], s43 offen lds
s_add_u32 m0, s48, 4096
s_nop 0
buffer_load_dwordx4 v244, s[44:47], s43 offen lds
s_add_u32 m0, s48, 5120
s_nop 0
buffer_load_dwordx4 v245, s[44:47], s43 offen lds
s_add_u32 m0, s48, 6144
s_nop 0
buffer_load_dwordx4 v246, s[44:47], s43 offen lds
g_69:
s_mov_b32 s44, s22
s_mov_b32 s45, s23
s_mov_b32 s46, 401408
s_mov_b32 s47, 0x20000
s_add_u32 s42, s52, 0
s_mul_i32 s48, s42, 7168
s_add_u32 s48, s48, 102400
s_add_u32 s42, s42, 7
s_mul_i32 s43, s42, 28672
s_add_u32 m0, s48, 0
s_nop 0
buffer_load_dwordx4 v240, s[44:47], s43 offen lds
s_add_u32 m0, s48, 1024
s_nop 0
buffer_load_dwordx4 v241, s[44:47], s43 offen lds
s_add_u32 m0, s48, 2048
s_nop 0
buffer_load_dwordx4 v242, s[44:47], s43 offen lds
s_add_u32 m0, s48, 3072
s_nop 0
buffer_load_dwordx4 v243, s[44:47], s43 offen lds
s_add_u32 m0, s48, 4096
s_nop 0
buffer_load_dwordx4 v244, s[44:47], s43 offen lds
s_add_u32 m0, s48, 5120
s_nop 0
buffer_load_dwordx4 v245, s[44:47], s43 offen lds
s_add_u32 m0, s48, 6144
s_nop 0
buffer_load_dwordx4 v246, s[44:47], s43 offen lds
g_70:
s_add_u32 s42, s52, 4
s_cmp_lt_u32 s42, 7
s_cbranch_scc0 g_71
s_mul_i32 s48, s42, 7168
s_add_u32 s48, s48, 102400
s_add_u32 s42, s42, 7
s_mul_i32 s43, s42, 28672
s_add_u32 m0, s48, 0
s_nop 0
buffer_load_dwordx4 v240, s[44:47], s43 offen lds
s_add_u32 m0, s48, 1024
s_nop 0
buffer_load_dwordx4 v241, s[44:47], s43 offen lds
s_add_u32 m0, s48, 2048
s_nop 0
buffer_load_dwordx4 v242, s[44:47], s43 offen lds
s_add_u32 m0, s48, 3072
s_nop 0
buffer_load_dwordx4 v243, s[44:47], s43 offen lds
s_add_u32 m0, s48, 4096
s_nop 0
buffer_load_dwordx4 v244, s[44:47], s43 offen lds
s_add_u32 m0, s48, 5120
s_nop 0
buffer_load_dwordx4 v245, s[44:47], s43 offen lds
s_add_u32 m0, s48, 6144
s_nop 0
buffer_load_dwordx4 v246, s[44:47], s43 offen lds
g_71:
s_waitcnt vmcnt(0)
s_mov_b64 exec, 1
ds_add_u32 v4, v5 offset:44
s_mov_b64 exec, -1
W_72:
ds_read_b32 v12, v4 offset:44
s_waitcnt lgkmcnt(0)
v_readfirstlane_b32 s39, v12
s_cmp_ge_u32 s39, 4
s_cbranch_scc1 D_73
s_sleep 2
s_sub_u32 s36, s36, 1
s_cbranch_scc0 W_72
s_mov_b32 s36, 0
D_73:
v_lshrrev_b32 v14, 2, v0
v_and_b32 v14, 3, v14
v_lshl_add_u32 v14, v2, 2, v14
v_mul_u32_u24 v14, 224, v14
v_bfe_u32 v13, v0, 4, 1
v_lshlrev_b32 v13, 5, v13
v_and_b32 v12, 3, v0
v_lshlrev_b32 v12, 3, v12
v_add3_u32 v14, v14, v13, v12
s_mul_i32 s40, s52, 56
s_add_u32 s40, s40, 49152
v_add_u32 v14, s40, v14
ds_read_b64_tr_b16 v[128:129], v14 offset:0
ds_read_b64_tr_b16 v[130:131], v14 offset:1792
ds_read_b64_tr_b16 v[132:133], v14 offset:3584
ds_read_b64_tr_b16 v[134:135], v14 offset:5376
ds_read_b64_tr_b16 v[136:137], v14 offset:6272
ds_read_b64_tr_b16 v[138:139], v14 offset:8064
ds_read_b64_tr_b16 v[140:141], v14 offset:9856
ds_read_b64_tr_b16 v[142:143], v14 offset:11648
ds_read_b64_tr_b16 v[144:145], v14 offset:12544
ds_read_b64_tr_b16 v[146:147], v14 offset:14336
ds_read_b64_tr_b16 v[148:149], v14 offset:16128
ds_read_b64_tr_b16 v[150:151], v14 offset:17920
ds_read_b64_tr_b16 v[152:153], v14 offset:18816
ds_read_b64_tr_b16 v[154:155], v14 offset:20608
ds_read_b64_tr_b16 v[156:157], v14 offset:22400
ds_read_b64_tr_b16 v[158:159], v14 offset:24192
ds_read_b64_tr_b16 v[160:161], v14 offset:25088
ds_read_b64_tr_b16 v[162:163], v14 offset:26880
ds_read_b64_tr_b16 v[164:165], v14 offset:28672
ds_read_b64_tr_b16 v[166:167], v14 offset:30464
ds_read_b64_tr_b16 v[168:169], v14 offset:31360
ds_read_b64_tr_b16 v[170:171], v14 offset:33152
ds_read_b64_tr_b16 v[172:173], v14 offset:34944
ds_read_b64_tr_b16 v[174:175], v14 offset:36736
ds_read_b64_tr_b16 v[176:177], v14 offset:37632
ds_read_b64_tr_b16 v[178:179], v14 offset:39424
ds_read_b64_tr_b16 v[180:181], v14 offset:41216
ds_read_b64_tr_b16 v[182:183], v14 offset:43008
ds_read_b64_tr_b16 v[184:185], v14 offset:43904
ds_read_b64_tr_b16 v[186:187], v14 offset:45696
ds_read_b64_tr_b16 v[188:189], v14 offset:47488
ds_read_b64_tr_b16 v[190:191], v14 offset:49280
s_waitcnt lgkmcnt(0)
s_mov_b64 exec, 1
ds_add_u32 v4, v5 offset:56
s_mov_b64 exec, -1
v_mov_b32 v12, 0
v_cndmask_b32 v190, v190, v12, s[54:55]
v_cndmask_b32 v191, v191, v12, s[54:55]
SFIN:
s_mul_i32 s40, s62, 448
s_add_u32 s40, s40, 20480
v_lshl_add_u32 v6, v0, 3, s40
s_lshr_b32 s41, s61, 2
s_mul_i32 s41, s41, 136
s_add_u32 s41, s41, 4096
v_mov_b32 v7, s41
v_cmp_gt_u32 vcc, 56, v0
s_nop 1
v_cndmask_b32 v6, v7, v6, vcc
s_cmp_eq_u32 s52, 0
s_cbranch_scc0 po_74
P_76:
global_load_dwordx2 v[12:13], v6, s[30:31] sc1
s_waitcnt vmcnt(0)
v_cmp_ne_u32 vcc, s37, v12
v_cmp_ne_u32 s[50:51], s38, v13
s_or_b64 vcc, vcc, s[50:51]
s_cbranch_vccz D_77
s_sleep 8
s_sub_u32 s36, s36, 1
s_cbranch_scc0 P_76
s_mov_b32 s36, 0
D_77:
s_mov_b64 exec, 1
ds_add_u32 v4, v5 offset:68
s_mov_b64 exec, -1
s_branch pd_75
po_74:
W_78:
ds_read_b32 v12, v4 offset:68
s_waitcnt lgkmcnt(0)
v_readfirstlane_b32 s39, v12
s_cmp_ge_u32 s39, 1
s_cbranch_scc1 D_79
s_sleep 4
s_sub_u32 s36, s36, 1
s_cbranch_scc0 W_78
s_mov_b32 s36, 0
D_79:
pd_75:
s_lshl_b32 s40, s61, 7
s_add_u32 s40, s40, 15728640
v_lshl_add_u32 v7, v1, 2, s40
global_load_dword v16, v7, s[30:31] sc1
s_mul_i32 s40, s62, 112
s_mul_i32 s41, s52, 28
s_add_u32 s40, s40, s41
s_lshl_b32 s40, s40, 12
s_lshl_b32 s41, s61, 6
s_add_u32 s40, s40, s41
s_add_u32 s40, s40, 12582912
v_lshlrev_b32 v6, 14, v2
v_lshl_add_u32 v6, v1, 1, v6
v_add_u32 v6, s40, v6
v_add_u32 v7, 0, v6
global_load_ushort v32, v7, s[30:31] sc1
v_add_u32 v7, 4096, v6
global_load_ushort v33, v7, s[30:31] sc1
v_add_u32 v7, 8192, v6
global_load_ushort v34, v7, s[30:31] sc1
v_add_u32 v7, 12288, v6
global_load_ushort v35, v7, s[30:31] sc1
v_add_u32 v7, 32768, v6
global_load_ushort v36, v7, s[30:31] sc1
v_add_u32 v7, 36864, v6
global_load_ushort v37, v7, s[30:31] sc1
v_add_u32 v7, 40960, v6
global_load_ushort v38, v7, s[30:31] sc1
v_add_u32 v7, 45056, v6
global_load_ushort v39, v7, s[30:31] sc1
v_add_u32 v7, 65536, v6
global_load_ushort v40, v7, s[30:31] sc1
v_add_u32 v7, 69632, v6
global_load_ushort v41, v7, s[30:31] sc1
v_add_u32 v7, 73728, v6
global_load_ushort v42, v7, s[30:31] sc1
v_add_u32 v7, 77824, v6
global_load_ushort v43, v7, s[30:31] sc1
v_add_u32 v7, 98304, v6
v_subrev_u32 v12, 16384, v7
v_cndmask_b32 v7, v7, v12, s[54:55]
global_load_ushort v44, v7, s[30:31] sc1
v_add_u32 v7, 102400, v6
v_subrev_u32 v12, 16384, v7
v_cndmask_b32 v7, v7, v12, s[54:55]
global_load_ushort v45, v7, s[30:31] sc1
v_add_u32 v7, 106496, v6
v_subrev_u32 v12, 16384, v7
v_cndmask_b32 v7, v7, v12, s[54:55]
global_load_ushort v46, v7, s[30:31] sc1
v_add_u32 v7, 110592, v6
v_subrev_u32 v12, 16384, v7
v_cndmask_b32 v7, v7, v12, s[54:55]
global_load_ushort v47, v7, s[30:31] sc1
s_or_b32 s40, s2, s52
s_cmp_eq_u32 s40, 0
s_cbranch_scc0 n0_80
v_lshlrev_b32 v7, 3, v0
v_add_u32 v7, 4096, v7
s_mov_b32 s41, 4
NQL:
P_81:
global_load_dwordx2 v[12:13], v7, s[30:31] sc1
s_waitcnt vmcnt(0)
v_cmp_ne_u32 vcc, s37, v12
v_cmp_ne_u32 s[50:51], s38, v13
s_or_b64 vcc, vcc, s[50:51]
s_cbranch_vccz D_82
s_sleep 8
s_sub_u32 s36, s36, 1
s_cbranch_scc0 P_81
s_mov_b32 s36, 0
D_82:
v_add_u32 v7, 512, v7
s_sub_u32 s41, s41, 1
s_cmp_lg_u32 s41, 0
s_cbranch_scc1 NQL
n0_80:
s_waitcnt vmcnt(0)
v_cvt_pk_bf16_f32 v16, v16, v16
v_lshlrev_b32 v16, 16, v16
v_mul_f32 v16, 0xbfb8aa3b, v16
v_exp_f32 v16, v16
s_nop 0
v_add_f32 v16, 1.0, v16
v_rcp_f32 v16, v16
s_nop 0
v_cvt_pk_bf16_f32 v16, v16, v16
v_lshlrev_b32 v8, 16, v16
v_sub_f32 v9, 1.0, v8
v_cvt_pk_bf16_f32 v9, v9, v9
v_lshlrev_b32 v9, 16, v9
v_lshlrev_b32 v32, 16, v32
v_lshlrev_b32 v33, 16, v33
v_lshlrev_b32 v34, 16, v34
v_lshlrev_b32 v35, 16, v35
v_lshlrev_b32 v36, 16, v36
v_lshlrev_b32 v37, 16, v37
v_lshlrev_b32 v38, 16, v38
v_lshlrev_b32 v39, 16, v39
v_lshlrev_b32 v40, 16, v40
v_lshlrev_b32 v41, 16, v41
v_lshlrev_b32 v42, 16, v42
v_lshlrev_b32 v43, 16, v43
v_lshlrev_b32 v44, 16, v44
v_lshlrev_b32 v45, 16, v45
v_lshlrev_b32 v46, 16, v46
v_lshlrev_b32 v47, 16, v47
v_pk_mul_f32 v[32:33], v[32:33], v[8:9] op_sel_hi:[1,0]
v_pk_mul_f32 v[34:35], v[34:35], v[8:9] op_sel_hi:[1,0]
v_pk_mul_f32 v[36:37], v[36:37], v[8:9] op_sel_hi:[1,0]
v_pk_mul_f32 v[38:39], v[38:39], v[8:9] op_sel_hi:[1,0]
v_pk_mul_f32 v[40:41], v[40:41], v[8:9] op_sel_hi:[1,0]
v_pk_mul_f32 v[42:43], v[42:43], v[8:9] op_sel_hi:[1,0]
v_pk_mul_f32 v[44:45], v[44:45], v[8:9] op_sel_hi:[1,0]
v_pk_mul_f32 v[46:47], v[46:47], v[8:9] op_sel_hi:[1,0]
s_lshr_b32 s40, s61, 2
s_lshl_b32 s40, s40, 7
s_add_u32 s40, s40, 16384
v_and_b32 v6, 15, v0
v_lshl_add_u32 v6, v6, 3, s40
s_lshl_b32 s40, s61, 15
s_add_u32 s40, s40, 8388608
v_lshl_add_u32 v7, v0, 4, s40
s_lshl_b32 s40, s61, 5
v_add_u32 v14, s40, v1
v_mul_u32_u24 v14, 896, v14
s_mul_i32 s40, s62, 224
s_mul_i32 s41, s52, 56
s_add_u32 s40, s40, s41
v_lshl_add_u32 v15, v2, 3, s40
v_add_u32 v14, v14, v15
v_lshrrev_b32 v11, 2, v0
v_and_b32 v11, 3, v11
v_lshl_add_u32 v11, v2, 2, v11
v_mul_u32_u24 v11, 224, v11
v_bfe_u32 v13, v0, 4, 1
v_lshlrev_b32 v13, 5, v13
v_and_b32 v12, 3, v0
v_lshlrev_b32 v12, 3, v12
v_add3_u32 v11, v11, v13, v12
s_mul_i32 s40, s52, 56
s_add_u32 s40, s40, 49152
v_add_u32 v11, s40, v11
v_add_u32 v11, 53248, v11
s_mov_b64 exec, 1
ds_add_u32 v4, v5 offset:52
s_mov_b64 exec, -1
W_83:
ds_read_b32 v12, v4 offset:52
s_waitcnt lgkmcnt(0)
v_readfirstlane_b32 s39, v12
s_cmp_ge_u32 s39, 4
s_cbranch_scc1 D_84
s_sleep 2
s_sub_u32 s36, s36, 1
s_cbranch_scc0 W_83
s_mov_b32 s36, 0
D_84:
ds_read_b64_tr_b16 v[48:49], v11 offset:0
ds_read_b64_tr_b16 v[50:51], v11 offset:1792
ds_read_b64_tr_b16 v[52:53], v11 offset:3584
ds_read_b64_tr_b16 v[54:55], v11 offset:5376
ds_read_b64_tr_b16 v[56:57], v11 offset:6272
ds_read_b64_tr_b16 v[58:59], v11 offset:8064
ds_read_b64_tr_b16 v[60:61], v11 offset:9856
ds_read_b64_tr_b16 v[62:63], v11 offset:11648
s_barrier
s_cmp_eq_u32 s52, 0
s_cbranch_scc0 po_85
P_87:
global_load_dwordx2 v[12:13], v6, s[30:31] sc1
s_waitcnt vmcnt(0)
v_cmp_ne_u32 vcc, s37, v12
v_cmp_ne_u32 s[50:51], s38, v13
s_or_b64 vcc, vcc, s[50:51]
s_cbranch_vccz D_88
s_sub_u32 s36, s36, 1
s_cbranch_scc0 P_87
s_mov_b32 s36, 0
D_88:
s_mov_b64 exec, 1
ds_add_u32 v4, v5 offset:72
s_mov_b64 exec, -1
s_branch pd_86
po_85:
W_89:
ds_read_b32 v12, v4 offset:72
s_waitcnt lgkmcnt(0)
v_readfirstlane_b32 s39, v12
s_cmp_ge_u32 s39, 1
s_cbranch_scc1 D_90
s_sub_u32 s36, s36, 1
s_cbranch_scc0 W_89
s_mov_b32 s36, 0
D_90:
pd_86:
global_load_dwordx4 v[64:67], v7, s[30:31] offset:0 sc1
global_load_dwordx4 v[68:71], v7, s[30:31] offset:1024 sc1
global_load_dwordx4 v[72:75], v7, s[30:31] offset:2048 sc1
global_load_dwordx4 v[76:79], v7, s[30:31] offset:3072 sc1
v_add_u32 v7, 4096, v7
global_load_dwordx4 v[80:83], v7, s[30:31] offset:0 sc1
global_load_dwordx4 v[84:87], v7, s[30:31] offset:1024 sc1
global_load_dwordx4 v[88:91], v7, s[30:31] offset:2048 sc1
global_load_dwordx4 v[92:95], v7, s[30:31] offset:3072 sc1
v_add_u32 v7, 4096, v7
global_load_dwordx4 v[96:99], v7, s[30:31] offset:0 sc1
global_load_dwordx4 v[100:103], v7, s[30:31] offset:1024 sc1
global_load_dwordx4 v[104:107], v7, s[30:31] offset:2048 sc1
global_load_dwordx4 v[108:111], v7, s[30:31] offset:3072 sc1
v_add_u32 v7, 4096, v7
global_load_dwordx4 v[112:115], v7, s[30:31] offset:0 sc1
global_load_dwordx4 v[116:119], v7, s[30:31] offset:1024 sc1
global_load_dwordx4 v[120:123], v7, s[30:31] offset:2048 sc1
global_load_dwordx4 v[124:127], v7, s[30:31] offset:3072 sc1
v_add_u32 v7, 4096, v7
global_load_dwordx4 v[192:195], v7, s[30:31] offset:0 sc1
global_load_dwordx4 v[196:199], v7, s[30:31] offset:1024 sc1
global_load_dwordx4 v[200:203], v7, s[30:31] offset:2048 sc1
global_load_dwordx4 v[204:207], v7, s[30:31] offset:3072 sc1
v_add_u32 v7, 4096, v7
global_load_dwordx4 v[208:211], v7, s[30:31] offset:0 sc1
global_load_dwordx4 v[212:215], v7, s[30:31] offset:1024 sc1
global_load_dwordx4 v[216:219], v7, s[30:31] offset:2048 sc1
global_load_dwordx4 v[220:223], v7, s[30:31] offset:3072 sc1
v_add_u32 v7, 4096, v7
global_load_dwordx4 v[224:227], v7, s[30:31] offset:0 sc1
global_load_dwordx4 v[228:231], v7, s[30:31] offset:1024 sc1
global_load_dwordx4 v[232:235], v7, s[30:31] offset:2048 sc1
global_load_dwordx4 v[236:239], v7, s[30:31] offset:3072 sc1
v_add_u32 v7, 4096, v7
global_load_dwordx4 v[240:243], v7, s[30:31] offset:0 sc1
global_load_dwordx4 v[244:247], v7, s[30:31] offset:1024 sc1
global_load_dwordx4 v[248:251], v7, s[30:31] offset:2048 sc1
global_load_dwordx4 v[252:255], v7, s[30:31] offset:3072 sc1
s_waitcnt vmcnt(31)
v_mfma_f32_32x32x16_bf16 v[16:31], v[128:131], v[64:67], 0
s_waitcnt vmcnt(30)
v_mfma_f32_32x32x16_bf16 v[16:31], v[132:135], v[68:71], v[16:31]
s_waitcnt vmcnt(29)
v_mfma_f32_32x32x16_bf16 v[16:31], v[136:139], v[72:75], v[16:31]
s_waitcnt vmcnt(28)
v_mfma_f32_32x32x16_bf16 v[16:31], v[140:143], v[76:79], v[16:31]
s_waitcnt vmcnt(27)
v_mfma_f32_32x32x16_bf16 v[16:31], v[144:147], v[80:83], v[16:31]
s_waitcnt vmcnt(26)
v_mfma_f32_32x32x16_bf16 v[16:31], v[148:151], v[84:87], v[16:31]
s_waitcnt vmcnt(25)
v_mfma_f32_32x32x16_bf16 v[16:31], v[152:155], v[88:91], v[16:31]
s_waitcnt vmcnt(24)
v_mfma_f32_32x32x16_bf16 v[16:31], v[156:159], v[92:95], v[16:31]
s_waitcnt vmcnt(23)
v_mfma_f32_32x32x16_bf16 v[16:31], v[160:163], v[96:99], v[16:31]
s_waitcnt vmcnt(22)
v_mfma_f32_32x32x16_bf16 v[16:31], v[164:167], v[100:103], v[16:31]
s_waitcnt vmcnt(21)
v_mfma_f32_32x32x16_bf16 v[16:31], v[168:171], v[104:107], v[16:31]
s_waitcnt vmcnt(20)
v_mfma_f32_32x32x16_bf16 v[16:31], v[172:175], v[108:111], v[16:31]
s_waitcnt vmcnt(19)
v_mfma_f32_32x32x16_bf16 v[16:31], v[176:179], v[112:115], v[16:31]
s_waitcnt vmcnt(18)
v_mfma_f32_32x32x16_bf16 v[16:31], v[180:183], v[116:119], v[16:31]
s_waitcnt vmcnt(17)
v_mfma_f32_32x32x16_bf16 v[16:31], v[184:187], v[120:123], v[16:31]
s_waitcnt vmcnt(16)
v_mfma_f32_32x32x16_bf16 v[16:31], v[188:191], v[124:127], v[16:31]
s_waitcnt vmcnt(15)
s_waitcnt lgkmcnt(6)
v_mfma_f32_32x32x16_bf16 v[16:31], v[48:51], v[192:195], v[16:31]
s_nop 7
ds_read_b64_tr_b16 v[48:49], v11 offset:12544
ds_read_b64_tr_b16 v[50:51], v11 offset:14336
s_waitcnt vmcnt(14)
s_waitcnt lgkmcnt(6)
v_mfma_f32_32x32x16_bf16 v[16:31], v[52:55], v[196:199], v[16:31]
s_nop 7
ds_read_b64_tr_b16 v[52:53], v11 offset:16128
ds_read_b64_tr_b16 v[54:55], v11 offset:17920
s_waitcnt vmcnt(13)
s_waitcnt lgkmcnt(6)
v_mfma_f32_32x32x16_bf16 v[16:31], v[56:59], v[200:203], v[16:31]
s_nop 7
ds_read_b64_tr_b16 v[56:57], v11 offset:18816
ds_read_b64_tr_b16 v[58:59], v11 offset:20608
s_waitcnt vmcnt(12)
s_waitcnt lgkmcnt(6)
v_mfma_f32_32x32x16_bf16 v[16:31], v[60:63], v[204:207], v[16:31]
s_nop 7
ds_read_b64_tr_b16 v[60:61], v11 offset:22400
ds_read_b64_tr_b16 v[62:63], v11 offset:24192
s_waitcnt vmcnt(11)
s_waitcnt lgkmcnt(6)
v_mfma_f32_32x32x16_bf16 v[16:31], v[48:51], v[208:211], v[16:31]
s_nop 7
ds_read_b64_tr_b16 v[48:49], v11 offset:25088
ds_read_b64_tr_b16 v[50:51], v11 offset:26880
s_waitcnt vmcnt(10)
s_waitcnt lgkmcnt(6)
v_mfma_f32_32x32x16_bf16 v[16:31], v[52:55], v[212:215], v[16:31]
s_nop 7
ds_read_b64_tr_b16 v[52:53], v11 offset:28672
ds_read_b64_tr_b16 v[54:55], v11 offset:30464
s_waitcnt vmcnt(9)
s_waitcnt lgkmcnt(6)
v_mfma_f32_32x32x16_bf16 v[16:31], v[56:59], v[216:219], v[16:31]
s_nop 7
ds_read_b64_tr_b16 v[56:57], v11 offset:31360
ds_read_b64_tr_b16 v[58:59], v11 offset:33152
s_waitcnt vmcnt(8)
s_waitcnt lgkmcnt(6)
v_mfma_f32_32x32x16_bf16 v[16:31], v[60:63], v[220:223], v[16:31]
s_nop 7
ds_read_b64_tr_b16 v[60:61], v11 offset:34944
ds_read_b64_tr_b16 v[62:63], v11 offset:36736
s_waitcnt vmcnt(7)
s_waitcnt lgkmcnt(6)
v_mfma_f32_32x32x16_bf16 v[16:31], v[48:51], v[224:227], v[16:31]
s_nop 7
ds_read_b64_tr_b16 v[48:49], v11 offset:37632
ds_read_b64_tr_b16 v[50:51], v11 offset:39424
s_waitcnt vmcnt(6)
s_waitcnt lgkmcnt(6)
v_mfma_f32_32x32x16_bf16 v[16:31], v[52:55], v[228:231], v[16:31]
s_nop 7
ds_read_b64_tr_b16 v[52:53], v11 offset:41216
ds_read_b64_tr_b16 v[54:55], v11 offset:43008
s_waitcnt vmcnt(5)
s_waitcnt lgkmcnt(6)
v_mfma_f32_32x32x16_bf16 v[16:31], v[56:59], v[232:235], v[16:31]
s_nop 7
ds_read_b64_tr_b16 v[56:57], v11 offset:43904
ds_read_b64_tr_b16 v[58:59], v11 offset:45696
s_waitcnt vmcnt(4)
s_waitcnt lgkmcnt(6)
v_mfma_f32_32x32x16_bf16 v[16:31], v[60:63], v[236:239], v[16:31]
s_nop 7
ds_read_b64_tr_b16 v[60:61], v11 offset:47488
ds_read_b64_tr_b16 v[62:63], v11 offset:49280
s_waitcnt vmcnt(3)
s_waitcnt lgkmcnt(6)
v_mfma_f32_32x32x16_bf16 v[16:31], v[48:51], v[240:243], v[16:31]
s_waitcnt vmcnt(2)
s_waitcnt lgkmcnt(4)
v_mfma_f32_32x32x16_bf16 v[16:31], v[52:55], v[244:247], v[16:31]
s_waitcnt vmcnt(1)
s_waitcnt lgkmcnt(2)
v_mfma_f32_32x32x16_bf16 v[16:31], v[56:59], v[248:251], v[16:31]
s_waitcnt vmcnt(0)
s_waitcnt lgkmcnt(0)
v_mov_b32 v12, 0
v_cndmask_b32 v62, v62, v12, s[54:55]
v_cndmask_b32 v63, v63, v12, s[54:55]
s_nop 1
v_mfma_f32_32x32x16_bf16 v[16:31], v[60:63], v[252:255], v[16:31]
s_nop 7
s_nop 7
v_pk_fma_f32 v[16:17], v[16:17], v[8:9], v[32:33] op_sel:[0,1,0] op_sel_hi:[1,1,1]
v_pk_fma_f32 v[18:19], v[18:19], v[8:9], v[34:35] op_sel:[0,1,0] op_sel_hi:[1,1,1]
v_pk_fma_f32 v[20:21], v[20:21], v[8:9], v[36:37] op_sel:[0,1,0] op_sel_hi:[1,1,1]
v_pk_fma_f32 v[22:23], v[22:23], v[8:9], v[38:39] op_sel:[0,1,0] op_sel_hi:[1,1,1]
v_pk_fma_f32 v[24:25], v[24:25], v[8:9], v[40:41] op_sel:[0,1,0] op_sel_hi:[1,1,1]
v_pk_fma_f32 v[26:27], v[26:27], v[8:9], v[42:43] op_sel:[0,1,0] op_sel_hi:[1,1,1]
v_pk_fma_f32 v[28:29], v[28:29], v[8:9], v[44:45] op_sel:[0,1,0] op_sel_hi:[1,1,1]
v_pk_fma_f32 v[30:31], v[30:31], v[8:9], v[46:47] op_sel:[0,1,0] op_sel_hi:[1,1,1]
v_cvt_pk_bf16_f32 v128, v16, v17
v_cvt_pk_bf16_f32 v129, v18, v19
v_cvt_pk_bf16_f32 v130, v20, v21
v_cvt_pk_bf16_f32 v131, v22, v23
v_cvt_pk_bf16_f32 v132, v24, v25
v_cvt_pk_bf16_f32 v133, v26, v27
v_cvt_pk_bf16_f32 v134, v28, v29
v_cvt_pk_bf16_f32 v135, v30, v31
global_store_dwordx2 v14, v[128:129], s[26:27] offset:0
global_store_dwordx2 v14, v[130:131], s[26:27] offset:16
global_store_dwordx2 v14, v[132:133], s[26:27] offset:32
s_mov_b32 exec_hi, 0
global_store_dwordx2 v14, v[134:135], s[26:27] offset:48
s_mov_b64 exec, -1
s_or_b32 s40, s2, s52
s_cmp_eq_u32 s40, 0
s_cbranch_scc0 n1_91
v_mov_b32 v6, 0
v_mov_b32 v7, s37
s_mov_b64 exec, 1
global_store_dword v6, v7, s[30:31] sc1
s_mov_b64 exec, -1
n1_91:
KEND:
s_endpgm
.section .rodata,"a"
.p2align 6
.amdhsa_kernel gated_mix__ssm_conv_s4d__softmax_full_mha__prompt_kernel
  .amdhsa_next_free_vgpr 256
  .amdhsa_next_free_sgpr 102
  .amdhsa_accum_offset 256
  .amdhsa_group_segment_fixed_size 0
  .amdhsa_kernarg_size 112
  .amdhsa_user_sgpr_count 2
  .amdhsa_user_sgpr_kernarg_segment_ptr 1
  .amdhsa_system_sgpr_workgroup_id_x 1
.end_amdhsa_kernel
```
